```python
import torch

def _softmax(x, axis=-1):
    return torch.softmax(x, dim=axis)
def _gelu(x):
    return torch.nn.functional.gelu(x, approximate="tanh")
def _silu(x):
    return torch.nn.functional.silu(x)
def _sigmoid(x):
    return torch.sigmoid(x)
def _layernorm(x, axis=-1, eps=1e-5):
    m = x.mean(dim=axis, keepdim=True)
    v = x.var(dim=axis, keepdim=True, unbiased=False)
    return (x - m) / torch.sqrt(v + eps)
def _scatter_add(tgt, idx, src, axis=0):
    return tgt.clone().index_add_(axis, idx, src)
def _segment_sum(src, seg, n):
    out = torch.zeros((n,) + src.shape[1:], dtype=src.dtype)
    return out.index_add_(0, seg, src)
def _pad(x, pw):
    flat = tuple(v for pair in reversed(pw) for v in pair)
    return torch.nn.functional.pad(x, flat)

kernel_name = 'standalone__mpnn_edge_mlp__graph'

def setup_inputs():

    _w = (lambda a: (lambda t: t.to(torch.bfloat16) if t.is_floating_point() else t)(torch.as_tensor(a)))
    N, deg, D, De = 10000, 32, 128, max(16, 1)
    E = N * deg
    return {
        "x": _w((lambda *s: torch.randn(*s, dtype=torch.bfloat16) * 0.05)(N, D)),
        "e_attr": _w((lambda *s: torch.randn(*s, dtype=torch.bfloat16) * 0.4)(E, De)),
        "src": _w((lambda lo, hi, *s: torch.randint(lo, hi, s))(0, N, E).to(torch.int64)),
        "dst": _w((lambda lo, hi, *s: torch.randint(lo, hi, s))(0, N, E).to(torch.int64)),
        "w_msg": _w((lambda *s: torch.randn(*s, dtype=torch.bfloat16) * 0.4)(2 * D + De, D)),
        "w_upd": _w((lambda *s: torch.randn(*s, dtype=torch.bfloat16) * 0.05)(2 * D, D)),
    }

def reference(x, e_attr, src, dst, w_msg, w_upd):
    N, D = x.shape
    m_in = torch.concatenate([x[src], x[dst], e_attr], axis=-1)
    msg = _silu(m_in @ w_msg)
    agg = _segment_sum(msg, dst, N)
    return _silu(torch.concatenate([x, agg], axis=-1) @ w_upd)
```

```asm
; @launch grid=(253,1,1) block=(512,1,1) lds=162048
.amdgcn_target "amdgcn-amd-amdhsa--gfx950"
.text
.globl standalone__mpnn_edge_mlp__graph_kernel
.p2align 8
.type standalone__mpnn_edge_mlp__graph_kernel,@function
standalone__mpnn_edge_mlp__graph_kernel:
  s_cmp_ge_u32 s2, 253
  s_cbranch_scc1 K_END
  s_load_dwordx16 s[4:19], s[0:1], 0
  s_load_dwordx2 s[20:21], s[0:1], 64
  v_lshrrev_b32 v1, 6, v0
  v_and_b32 v5, 63, v0
  v_readfirstlane_b32 s3, v1
  v_lshlrev_b32 v4, 4, v5
  s_getpc_b64 s[22:23]
K_PC:
  s_lshr_b32 s80, s2, 3
  s_mul_i32 s80, s80, ((K_CODE_END-K_PC)/32+127)&~127
  v_lshl_add_u32 v9, v5, 3, s80
  v_min_u32 v9, K_CODE_END-K_PC-4, v9
  global_load_dword v8, v9, s[22:23]
  s_getpc_b64 s[80:81]
  s_add_u32 s80, s80, K_TABLE@rel32@lo+4
  s_addc_u32 s81, s81, K_TABLE@rel32@hi+12
  global_load_dwordx4 v[52:55], v4, s[80:81] offset:3072
  global_load_dwordx4 v[16:19], v4, s[80:81]
  global_load_dwordx4 v[20:23], v4, s[80:81] offset:1024
  global_load_dwordx4 v[48:51], v4, s[80:81] offset:2048
  v_lshlrev_b32 v3, 4, v0
  v_lshrrev_b32 v56, 2, v4
  v_lshrrev_b32 v57, 4, v3
  v_and_b32 v56, 0xc0, v56
  v_and_b32 v57, 0xf0, v57
  v_xor_b32 v56, v56, v4
  v_xor_b32 v57, v57, v3
  s_lshr_b32 s52, s3, 2
  s_and_b32 s53, s3, 3
  s_cmp_lt_u32 s2, 3
  s_cbranch_scc1 K_SPECIAL
  s_sub_u32 s23, s2, 3
  s_lshr_b32 s101, s23, 3
  s_cmp_ge_u32 s23, 125
  s_cselect_b32 s62, 0, 1
  s_cselect_b32 s22, 125, 0
  s_sub_u32 s89, s23, s22
  s_lshl_b32 s2, s89, 1
  s_add_u32 s2, s2, s62
  s_mul_i32 s82, s89, 20480
  s_sub_u32 s38, 2560000, s82
  s_mov_b32 s39, 0x00020000
  s_lshl_b32 s76, s3, 10
  s_add_u32 s77, s3, s101
  s_and_b32 s77, s77, 7

  s_lshl_b32 s77, s77, 12
  s_cmp_eq_u32 s62, 0
  s_waitcnt lgkmcnt(0)

  s_mov_b32 s22, 2621184
  s_load_dword s57, s[20:21], s22
  s_cbranch_scc1 K_BIN
  s_add_u32 s36, s4, s82
  s_addc_u32 s37, s5, 0
  s_add_u32 m0, s76, 95488
  s_movk_i32 s23, 0x2000
  buffer_load_dwordx4 v57, s[36:39], 0 offen lds
  s_add_u32 m0, s76, 103680
  s_movk_i32 s22, 0x4000
  buffer_load_dwordx4 v57, s[36:39], s23 offen lds

  s_add_u32 m0, s76, 111872
  s_nop 0
  buffer_load_dwordx4 v57, s[36:39], s22 offen lds
  s_mov_b32 s64, s12
  s_mov_b32 s65, s13
  s_mov_b32 s66, 69632
  s_mov_b32 s67, 0x00020000
  s_add_u32 m0, s77, 0
  s_nop 0
  buffer_load_dwordx4 v56, s[64:67], s77 offen offset:0 lds
  buffer_load_dwordx4 v56, s[64:67], s77 offen offset:1024 lds
  buffer_load_dwordx4 v56, s[64:67], s77 offen offset:2048 lds
  buffer_load_dwordx4 v56, s[64:67], s77 offen offset:3072 lds
  s_branch K_GEMM
K_BIN:
  s_mul_i32 s22, s89, 10240
  s_add_u32 s44, s10, s22
  s_addc_u32 s45, s11, 0
  s_mov_b32 s46, 10240
  s_mov_b32 s47, 0x00020000
  v_lshlrev_b32 v2, 2, v0
  s_movk_i32 s23, 0x2000
  buffer_load_dwordx4 v[92:95], v3, s[44:47], 0 offen
  buffer_load_dword v96, v2, s[44:47], s23 offen

  s_add_u32 s48, s8, s22
  s_addc_u32 s49, s9, 0
  s_mov_b32 s50, 10240
  s_mov_b32 s51, 0x00020000
  buffer_load_dwordx4 v[100:103], v3, s[48:51], 0 offen
  buffer_load_dword v104, v2, s[48:51], s23 offen
  v_mov_b64 v[124:125], -1
  v_mov_b64 v[126:127], -1
  v_mov_b32 v128, 16
  ds_write_b128 v3, v[124:127]
  ds_write_b128 v3, v[124:127] offset:8192
  ds_write_b128 v3, v[124:127] offset:16384
  ds_write_b128 v3, v[124:127] offset:24576
  ds_write_b32 v2, v128 offset:32768

  s_mov_b32 s64, s12
  s_mov_b32 s65, s13
  s_mov_b32 s66, 69632
  s_mov_b32 s67, 0x00020000
  s_mov_b32 s24, s20
  s_mov_b32 s25, s21
  s_mov_b32 s26, 7438336
  s_mov_b32 s27, 0x00020000
  s_mov_b32 s28, s20
  s_or_b32 s29, s21, 0x1000000
  s_mov_b32 s30, 10000
  s_mov_b32 s31, 0x00020000
  s_mov_b32 s32, s6
  s_or_b32 s33, s7, 0x200000
  s_mov_b32 s34, 320000
  s_mov_b32 s35, 0x00020000
  s_mov_b32 s40, s16
  s_mov_b32 s41, s17
  s_mov_b32 s42, 2560000
  s_mov_b32 s43, 0x00020000
  s_mov_b32 s60, 0
  s_mov_b32 s83, 0
  s_movk_i32 s84, 0x3fff
  s_lshl_b32 s58, s3, 13
  s_lshr_b32 s22, s53, 1
  s_mul_i32 s22, s22, 3072
  s_bfe_u32 s23, s53, 0x10000
  s_lshl_b32 s23, s23, 10
  s_add_u32 s22, s22, s23
  s_mul_i32 s63, s52, 43008
  s_add_u32 s100, s63, s22
  s_add_u32 s100, s100, 15616
  s_bfe_u32 s22, s2, 0x30001
  s_lshl_b32 s22, s22, 7
  s_mul_i32 s87, s2, 10240
  s_add_u32 s87, s87, s22
  s_add_u32 s87, s87, 9216

  v_lshlrev_b32 v130, 22, v0
  v_add_u32 v131, 0x800, v0
  v_lshlrev_b32 v131, 20, v131
  v_mov_b32 v129, 16
  s_mov_b32 s72, -10
  s_mov_b32 s73, 0x100000
  s_mov_b32 s74, 0x200000
  s_mov_b32 s75, 0x300000
  v_lshrrev_b32 v134, 2, v0
  v_and_b32 v135, 3, v0
  v_lshl_add_u32 v136, v134, 1, s89
  v_and_b32 v136, 127, v136
  v_lshl_or_b32 v135, v136, 2, v135
  v_lshlrev_b32 v135, 4, v135
  v_lshl_add_u32 v136, v134, 13, v135
  v_mul_u32_u24 v134, 10240, v134
  v_add_u32 v134, v134, v135
  s_movk_i32 s79, 496
  s_waitcnt lgkmcnt(0)
  s_barrier
  s_add_u32 s57, s57, 2
  s_or_b32 s57, s57, 0x40000001
  s_waitcnt vmcnt(2)

  v_mul_u32_u24 v116, 0xcccd, v92
  v_lshrrev_b32 v116, 19, v116
  v_and_b32 v116, -4, v116
  ds_add_rtn_u32 v108, v116, v129 offset:32768

  v_mul_u32_u24 v117, 0xcccd, v93
  v_lshrrev_b32 v117, 19, v117
  v_and_b32 v117, -4, v117
  ds_add_rtn_u32 v109, v117, v129 offset:32768

  v_mul_u32_u24 v118, 0xcccd, v94
  v_lshrrev_b32 v118, 19, v118
  v_and_b32 v118, -4, v118
  ds_add_rtn_u32 v110, v118, v129 offset:32768

  v_mul_u32_u24 v119, 0xcccd, v95
  v_lshrrev_b32 v119, 19, v119
  v_and_b32 v119, -4, v119
  ds_add_rtn_u32 v111, v119, v129 offset:32768

  v_mul_u32_u24 v120, 0xcccd, v96
  v_lshrrev_b32 v120, 19, v120
  v_and_b32 v120, -4, v120
  ds_add_rtn_u32 v112, v120, v129 offset:32768

  s_add_u32 s36, s4, s82
  s_addc_u32 s37, s5, 0
  s_add_u32 m0, s76, 95488
  s_movk_i32 s23, 0x2000
  buffer_load_dwordx4 v57, s[36:39], 0 offen lds
  s_add_u32 m0, s76, 103680
  s_movk_i32 s22, 0x4000
  buffer_load_dwordx4 v57, s[36:39], s23 offen lds

  s_add_u32 m0, s77, 120064
  s_add_u32 s22, s77, 32768
  buffer_load_dwordx4 v56, s[64:67], s22 offen offset:0 lds
  buffer_load_dwordx4 v56, s[64:67], s22 offen offset:1024 lds
  buffer_load_dwordx4 v56, s[64:67], s22 offen offset:2048 lds
  buffer_load_dwordx4 v56, s[64:67], s22 offen offset:3072 lds
  s_add_u32 m0, s76, 152832
  s_add_u32 s22, s76, 65536
  buffer_load_dwordx4 v56, s[64:67], s22 offen lds
  v_mad_i32_i24 v92, v116, s72, v92
  v_mad_i32_i24 v93, v117, s72, v93
  v_mad_i32_i24 v94, v118, s72, v94
  v_mad_i32_i24 v95, v119, s72, v95
  v_mad_i32_i24 v96, v120, s72, v96
  s_waitcnt vmcnt(7)
  v_lshl_or_b32 v92, v92, 14, v100
  v_add_u32 v92, v92, v130
  v_lshl_or_b32 v93, v93, 14, v101
  v_add3_u32 v93, v93, v130, s73
  v_lshl_or_b32 v94, v94, 14, v102
  v_add3_u32 v94, v94, v130, s74
  v_lshl_or_b32 v95, v95, 14, v103
  v_add3_u32 v95, v95, v130, s75
  v_lshl_or_b32 v96, v96, 14, v104
  v_add_u32 v96, v96, v131
  s_waitcnt lgkmcnt(0)
  v_max3_u32 v132, v108, v109, v110
  v_max3_u32 v132, v132, v111, v112
  v_cmp_le_u32 vcc, s79, v132
  s_cbranch_vccnz K_BOVF
K_BOVB:
  v_mov_b64 v[156:157], v[92:93]
  v_mov_b64 v[158:159], v[94:95]
  v_mov_b32 v160, v96
  v_lshrrev_b32 v132, 4, v108
  v_and_b32 v133, 0x100, v108
  v_and_b32 v108, 0x30, v108
  v_and_or_b32 v108, v132, 12, v108
  v_lshl_or_b32 v108, v133, 6, v108
  v_lshl_add_u32 v108, v116, 4, v108
  ds_write_b32 v108, v92

  v_lshrrev_b32 v132, 4, v109
  v_and_b32 v133, 0x100, v109
  v_and_b32 v109, 0x30, v109
  v_and_or_b32 v109, v132, 12, v109
  v_lshl_or_b32 v109, v133, 6, v109
  v_lshl_add_u32 v109, v117, 4, v109
  ds_write_b32 v109, v93

  v_lshrrev_b32 v132, 4, v110
  v_and_b32 v133, 0x100, v110
  v_and_b32 v110, 0x30, v110
  v_and_or_b32 v110, v132, 12, v110
  v_lshl_or_b32 v110, v133, 6, v110
  v_lshl_add_u32 v110, v118, 4, v110
  ds_write_b32 v110, v94

  v_lshrrev_b32 v132, 4, v111
  v_and_b32 v133, 0x100, v111
  v_and_b32 v111, 0x30, v111
  v_and_or_b32 v111, v132, 12, v111
  v_lshl_or_b32 v111, v133, 6, v111
  v_lshl_add_u32 v111, v119, 4, v111
  ds_write_b32 v111, v95

  v_lshrrev_b32 v132, 4, v112
  v_and_b32 v133, 0x100, v112
  v_and_b32 v112, 0x30, v112
  v_and_or_b32 v112, v132, 12, v112
  v_lshl_or_b32 v112, v133, 6, v112
  v_lshl_add_u32 v112, v120, 4, v112
  ds_write_b32 v112, v96

  s_mov_b32 s78, 0
  s_mov_b32 s73, 1310720
  s_mov_b32 s74, 2621440
  s_mov_b32 s75, 3670016
  s_movk_i32 s22, 488
  v_cmp_gt_u32 s[70:71], s22, v0
  s_not_b32 s22, s57
  s_waitcnt lgkmcnt(0)
  s_barrier

  ds_read_b128 v[92:95], v3
  ds_read_b128 v[96:99], v3 offset:8192
  ds_read_b128 v[100:103], v3 offset:16384
  ds_read_b128 v[104:107], v3 offset:24576
  s_waitcnt lgkmcnt(0)

  v_bitop3_b32 v108, v92, v93, v94 bitop3:0x96
  v_bitop3_b32 v109, v96, v97, v98 bitop3:0x96
  v_bitop3_b32 v110, v100, v101, v102 bitop3:0x96
  v_bitop3_b32 v111, v104, v105, v106 bitop3:0x96
  v_xor_b32 v108, v108, v95
  v_xor_b32 v109, v109, v99
  v_xor_b32 v110, v110, v103
  v_xor_b32 v111, v111, v107
  v_xor_b32_dpp v108, v108, v108 quad_perm:[1,0,3,2] row_mask:0xf bank_mask:0xf
  v_xor_b32_dpp v109, v109, v109 quad_perm:[1,0,3,2] row_mask:0xf bank_mask:0xf
  v_xor_b32_dpp v110, v110, v110 quad_perm:[1,0,3,2] row_mask:0xf bank_mask:0xf
  v_xor_b32_dpp v111, v111, v111 quad_perm:[1,0,3,2] row_mask:0xf bank_mask:0xf
  v_xor_b32_dpp v108, v108, v108 quad_perm:[2,3,0,1] row_mask:0xf bank_mask:0xf
  v_xor_b32_dpp v109, v109, v109 quad_perm:[2,3,0,1] row_mask:0xf bank_mask:0xf
  v_xor_b32_dpp v110, v110, v110 quad_perm:[2,3,0,1] row_mask:0xf bank_mask:0xf
  v_xor_b32_dpp v111, v111, v111 quad_perm:[2,3,0,1] row_mask:0xf bank_mask:0xf
  v_mov_b32_dpp v112, v100 quad_perm:[0,0,0,0] row_mask:0xf bank_mask:0xf
  v_mov_b32_dpp v113, v104 quad_perm:[0,0,0,0] row_mask:0xf bank_mask:0xf
  v_cmp_ne_u32 s[68:69], -1, v112
  v_cmp_ne_u32 vcc, -1, v113
  s_mov_b32 exec_lo, 0x11111111
  s_mov_b32 exec_hi, 0x11111111
  s_and_b64 s[70:71], s[70:71], vcc
  v_xor_b32 v92, s22, v108
  v_xor_b32 v96, s22, v109
  v_cndmask_b32 v112, 0, 1, s[68:69]
  v_cndmask_b32 v113, 0, 1, vcc
  v_xor_b32 v92, v92, v112
  v_xor_b32 v96, v96, v113
  s_mov_b32 exec_lo, 0x88888888
  s_mov_b32 exec_hi, 0x88888888
  v_xor_b32 v103, s22, v110
  v_xor_b32 v107, s22, v111
  s_mov_b64 exec, -1
  s_waitcnt vmcnt(0)
  buffer_store_dwordx4 v[92:95], v134, s[40:43], s78 offen sc0 sc1
  buffer_store_dwordx4 v[96:99], v134, s[40:43], s73 offen sc0 sc1
  s_mov_b64 exec, s[68:69]
  buffer_store_dwordx4 v[100:103], v136, s[24:27], s74 offen sc0 sc1
  s_mov_b64 exec, s[70:71]
  buffer_store_dwordx4 v[104:107], v136, s[24:27], s75 offen sc0 sc1
  s_mov_b64 exec, -1

  s_add_u32 s22, s89, 0
  s_mul_i32 s23, s89, 2560
  v_lshrrev_b32 v164, 3, v116
  v_bfe_u32 v165, v116, 2, 1
  v_mad_u32_u24 v164, v165, 3, v164
  v_subrev_u32 v164, s22, v164
  v_and_b32 v164, 7, v164
  v_bfe_u32 v165, v156, 14, 6
  v_lshrrev_b32 v156, 20, v156
  v_lshl_or_b32 v164, v164, 8, v165
  v_subrev_u32 v165, 21, v164
  v_add_u32 v156, s23, v156
  v_min_u32 v164, v164, v165
  v_cmpx_gt_u32 vcc, 10, v164
  buffer_load_dword v11, v156, s[32:35], 0 idxen
  s_mov_b64 exec, -1

  v_lshrrev_b32 v164, 3, v117
  v_bfe_u32 v165, v117, 2, 1
  v_mad_u32_u24 v164, v165, 3, v164
  v_subrev_u32 v164, s22, v164
  v_and_b32 v164, 7, v164
  v_bfe_u32 v165, v157, 14, 6
  v_lshrrev_b32 v157, 20, v157
  v_lshl_or_b32 v164, v164, 8, v165
  v_subrev_u32 v165, 21, v164
  v_add_u32 v157, s23, v157
  v_min_u32 v164, v164, v165
  v_cmpx_gt_u32 vcc, 10, v164
  buffer_load_dword v11, v157, s[32:35], 0 idxen
  s_mov_b64 exec, -1

  v_lshrrev_b32 v164, 3, v118
  v_bfe_u32 v165, v118, 2, 1
  v_mad_u32_u24 v164, v165, 3, v164
  v_subrev_u32 v164, s22, v164
  v_and_b32 v164, 7, v164
  v_bfe_u32 v165, v158, 14, 6
  v_lshrrev_b32 v158, 20, v158
  v_lshl_or_b32 v164, v164, 8, v165
  v_subrev_u32 v165, 21, v164
  v_add_u32 v158, s23, v158
  v_min_u32 v164, v164, v165
  v_cmpx_gt_u32 vcc, 10, v164
  buffer_load_dword v11, v158, s[32:35], 0 idxen
  s_mov_b64 exec, -1

  v_lshrrev_b32 v164, 3, v119
  v_bfe_u32 v165, v119, 2, 1
  v_mad_u32_u24 v164, v165, 3, v164
  v_subrev_u32 v164, s22, v164
  v_and_b32 v164, 7, v164
  v_bfe_u32 v165, v159, 14, 6
  v_lshrrev_b32 v159, 20, v159
  v_lshl_or_b32 v164, v164, 8, v165
  v_subrev_u32 v165, 21, v164
  v_add_u32 v159, s23, v159
  v_min_u32 v164, v164, v165
  v_cmpx_gt_u32 vcc, 10, v164
  buffer_load_dword v11, v159, s[32:35], 0 idxen
  s_mov_b64 exec, -1

  v_lshrrev_b32 v164, 3, v120
  v_bfe_u32 v165, v120, 2, 1
  v_mad_u32_u24 v164, v165, 3, v164
  v_subrev_u32 v164, s22, v164
  v_and_b32 v164, 7, v164
  v_bfe_u32 v165, v160, 14, 6
  v_lshrrev_b32 v160, 20, v160
  v_lshl_or_b32 v164, v164, 8, v165
  v_subrev_u32 v165, 21, v164
  v_add_u32 v160, s23, v160
  v_min_u32 v164, v164, v165
  v_cmpx_gt_u32 vcc, 10, v164
  buffer_load_dword v11, v160, s[32:35], 0 idxen
  s_mov_b64 exec, -1

  v_add_u32 v20, s58, v20
  v_add_u32 v16, s63, v16
  s_mul_i32 s22, s52, 7168
  v_xor_b32 v13, 16, v20
  v_add_u32 v17, s22, v17
  v_add_u32 v18, s22, v18
  s_lshl_b32 s23, s53, 8
  s_add_u32 s22, s22, s23
  v_add_u32 v19, s22, v19
  s_lshl_b32 s22, s53, 6
  v_or_b32 v25, s22, v50
  v_or_b32 v27, s22, v50
  v_xor_b32 v53, s22, v53
  s_mul_i32 s23, s2, 40
  s_mul_i32 s78, s52, 21
  s_add_u32 s23, s23, s78
  s_lshl_b32 s23, s23, 8
  s_add_u32 s23, s23, s22
  s_cmp_eq_u32 s52, 0
  s_cselect_b64 vcc, -1, 0
  v_cndmask_b32 v34, v55, v54, vcc
  v_add_u32 v34, s23, v34
  v_mov_b32 v29, v51
  v_lshrrev_b32 v21, 2, v0
  s_lshl_b32 s22, s2, 1
  v_subrev_u32 v21, s22, v21
  v_and_b32 v21, 127, v21
  v_mul_u32_u24 v21, 2560, v21
  s_mul_i32 s22, s3, 12288
  v_add_u32 v22, s22, v22
  s_lshl_b32 s22, s3, 2
  v_add_u32 v6, s22, v49
  s_lshl_b32 s22, s52, 4
  v_add_u32 v14, s22, v49
  v_lshrrev_b32 v58, 5, v5
  s_add_u32 s58, s58, 95488
  s_mul_i32 s63, s52, 36864
  s_add_u32 s63, s63, 58624

  s_branch K_COM0
K_GEMM:
  s_mov_b32 s24, s20
  s_mov_b32 s25, s21
  s_mov_b32 s26, 7438336
  s_mov_b32 s27, 0x00020000
  s_mov_b32 s28, s20
  s_or_b32 s29, s21, 0x1000000
  s_mov_b32 s30, 10000
  s_mov_b32 s31, 0x00020000
  s_mov_b32 s32, s6
  s_or_b32 s33, s7, 0x200000
  s_mov_b32 s34, 320000
  s_mov_b32 s35, 0x00020000
  s_mov_b32 s40, s16
  s_mov_b32 s41, s17
  s_mov_b32 s42, 2560000
  s_mov_b32 s43, 0x00020000
  s_mov_b32 s60, 0
  s_mov_b32 s83, 0
  s_movk_i32 s84, 0x3fff
  s_lshl_b32 s58, s3, 13
  s_lshr_b32 s22, s53, 1
  s_mul_i32 s22, s22, 3072
  s_bfe_u32 s23, s53, 0x10000
  s_lshl_b32 s23, s23, 10
  s_add_u32 s22, s22, s23
  s_mul_i32 s63, s52, 43008
  s_add_u32 s100, s63, s22
  s_add_u32 s100, s100, 15616
  s_bfe_u32 s22, s2, 0x30001
  s_lshl_b32 s22, s22, 7
  s_mul_i32 s87, s2, 10240
  s_add_u32 s87, s87, s22
  s_add_u32 s87, s87, 9216

  s_sub_u32 s89, s87, 1024
  s_mov_b32 s72, 0xbfb8aa3b
  s_add_u32 s73, s82, 0x2000
  s_add_u32 s74, s82, 0x4000
  s_cmp_ge_u32 s3, 4
  s_cselect_b32 s74, 0x40000000, s74

  v_add_u32 v11, 32768, v3
  v_and_b32 v124, 31, v5
  s_lshl_b32 s22, s52, 5
  v_add_u32 v124, s22, v124
  s_waitcnt vmcnt(7)

  v_add_u32 v20, s58, v20
  v_add_u32 v16, s63, v16
  s_mul_i32 s22, s52, 7168
  v_xor_b32 v13, 16, v20
  v_add_u32 v17, s22, v17
  v_add_u32 v18, s22, v18
  s_lshl_b32 s23, s53, 8
  s_add_u32 s22, s22, s23
  v_add_u32 v19, s22, v19
  s_lshl_b32 s22, s53, 6
  v_or_b32 v25, s22, v50
  v_or_b32 v27, s22, v50
  v_xor_b32 v53, s22, v53
  s_mul_i32 s23, s2, 40
  s_mul_i32 s78, s52, 21
  s_add_u32 s23, s23, s78
  s_lshl_b32 s23, s23, 8
  s_add_u32 s23, s23, s22
  s_cmp_eq_u32 s52, 0
  s_cselect_b64 vcc, -1, 0
  v_cndmask_b32 v34, v55, v54, vcc
  v_add_u32 v34, s23, v34
  v_mov_b32 v29, v51
  v_lshrrev_b32 v21, 2, v0
  s_lshl_b32 s22, s2, 1
  v_subrev_u32 v21, s22, v21
  v_and_b32 v21, 127, v21
  v_mul_u32_u24 v21, 2560, v21
  s_mul_i32 s22, s3, 12288
  v_add_u32 v22, s22, v22
  s_lshl_b32 s22, s3, 2
  v_add_u32 v6, s22, v49
  s_lshl_b32 s22, s52, 4
  v_add_u32 v14, s22, v49
  v_lshrrev_b32 v58, 5, v5
  s_add_u32 s58, s58, 95488
  s_mul_i32 s63, s52, 36864
  s_add_u32 s63, s63, 58624

  v_lshl_add_u32 v127, v58, 11, v53
  s_lshl_b32 s22, s53, 2
  v_lshl_add_u32 v125, v58, 1, s22
  v_xor_b32 v125, v125, v124
  v_and_b32 v125, 15, v125
  v_lshl_or_b32 v125, v124, 4, v125
  s_mov_b32 s22, 32768
  v_lshl_add_u32 v125, v125, 4, s22
  v_xor_b32 v126, v58, v124
  v_and_b32 v126, 15, v126
  v_lshl_or_b32 v124, v124, 4, v126
  s_mov_b32 s22, 95488
  v_lshl_add_u32 v124, v124, 4, s22

  v_xor_b32 v133, 32, v124
  v_xor_b32 v134, 64, v124
  v_xor_b32 v135, 96, v124
  v_xor_b32 v136, 128, v124
  v_xor_b32 v137, 160, v124
  v_xor_b32 v138, 192, v124
  v_xor_b32 v139, 224, v124
  s_waitcnt lgkmcnt(0)
  s_add_u32 s57, s57, 2
  s_or_b32 s57, s57, 0x40000001
  s_waitcnt vmcnt(0)
  s_barrier
  ds_read_b64_tr_b16 v[60:61], v127 offset:0
  ds_read_b64_tr_b16 v[62:63], v127 offset:1024
  ds_read_b128 v[220:223], v124
  ds_read_b64_tr_b16 v[64:65], v127 offset:4096
  ds_read_b64_tr_b16 v[66:67], v127 offset:5120
  ds_read_b128 v[224:227], v133
  ds_read_b64_tr_b16 v[68:69], v127 offset:8192
  ds_read_b64_tr_b16 v[70:71], v127 offset:9216
  ds_read_b128 v[228:231], v134
  ds_read_b64_tr_b16 v[72:73], v127 offset:12288
  ds_read_b64_tr_b16 v[74:75], v127 offset:13312
  ds_read_b128 v[232:235], v135
  ds_read_b64_tr_b16 v[76:77], v127 offset:16384
  ds_read_b64_tr_b16 v[78:79], v127 offset:17408
  ds_read_b128 v[236:239], v136
  ds_read_b64_tr_b16 v[80:81], v127 offset:20480
  ds_read_b64_tr_b16 v[82:83], v127 offset:21504
  ds_read_b128 v[240:243], v137
  ds_read_b64_tr_b16 v[84:85], v127 offset:24576
  ds_read_b64_tr_b16 v[86:87], v127 offset:25600
  ds_read_b128 v[244:247], v138
  ds_read_b64_tr_b16 v[88:89], v127 offset:28672
  ds_read_b64_tr_b16 v[90:91], v127 offset:29696
  ds_read_b128 v[248:251], v139
  s_add_u32 m0, s77, 120064
  s_add_u32 s22, s77, 32768
  buffer_load_dwordx4 v56, s[64:67], s22 offen offset:0 lds
  buffer_load_dwordx4 v56, s[64:67], s22 offen offset:1024 lds
  buffer_load_dwordx4 v56, s[64:67], s22 offen offset:2048 lds
  buffer_load_dwordx4 v56, s[64:67], s22 offen offset:3072 lds
  s_add_u32 m0, s76, 152832
  s_add_u32 s22, s76, 65536
  buffer_load_dwordx4 v56, s[64:67], s22 offen lds
  s_cmp_lg_u32 s52, 0
  s_cbranch_scc1 K_G1
  ds_read_b128 v[188:191], v124 offset:16384
  ds_read_b128 v[192:195], v133 offset:16384
  ds_read_b128 v[196:199], v134 offset:16384
  ds_read_b128 v[200:203], v135 offset:16384
  ds_read_b128 v[204:207], v136 offset:16384
  ds_read_b128 v[208:211], v137 offset:16384
  ds_read_b128 v[212:215], v138 offset:16384
  ds_read_b128 v[216:219], v139 offset:16384
  s_waitcnt lgkmcnt(15)
  v_mfma_f32_32x32x16_bf16 v[92:107], v[60:63], v[220:223], 0
  s_waitcnt lgkmcnt(15)
  v_mfma_f32_32x32x16_bf16 v[92:107], v[64:67], v[224:227], v[92:107]
  s_waitcnt lgkmcnt(15)
  v_mfma_f32_32x32x16_bf16 v[92:107], v[68:71], v[228:231], v[92:107]
  s_waitcnt lgkmcnt(15)
  v_mfma_f32_32x32x16_bf16 v[92:107], v[72:75], v[232:235], v[92:107]
  s_waitcnt lgkmcnt(15)
  v_mfma_f32_32x32x16_bf16 v[92:107], v[76:79], v[236:239], v[92:107]
  s_waitcnt lgkmcnt(14)
  v_mfma_f32_32x32x16_bf16 v[92:107], v[80:83], v[240:243], v[92:107]
  s_waitcnt lgkmcnt(11)
  v_mfma_f32_32x32x16_bf16 v[92:107], v[84:87], v[244:247], v[92:107]
  s_waitcnt lgkmcnt(8)
  v_mfma_f32_32x32x16_bf16 v[92:107], v[88:91], v[248:251], v[92:107]
  s_waitcnt lgkmcnt(7)
  v_mfma_f32_32x32x16_bf16 v[108:123], v[60:63], v[188:191], 0
  s_waitcnt lgkmcnt(6)
  v_mfma_f32_32x32x16_bf16 v[108:123], v[64:67], v[192:195], v[108:123]
  s_waitcnt lgkmcnt(5)
  v_mfma_f32_32x32x16_bf16 v[108:123], v[68:71], v[196:199], v[108:123]
  s_waitcnt lgkmcnt(4)
  v_mfma_f32_32x32x16_bf16 v[108:123], v[72:75], v[200:203], v[108:123]
  s_waitcnt lgkmcnt(3)
  v_mfma_f32_32x32x16_bf16 v[108:123], v[76:79], v[204:207], v[108:123]
  s_waitcnt lgkmcnt(2)
  v_mfma_f32_32x32x16_bf16 v[108:123], v[80:83], v[208:211], v[108:123]
  s_waitcnt lgkmcnt(1)
  v_mfma_f32_32x32x16_bf16 v[108:123], v[84:87], v[212:215], v[108:123]
  s_waitcnt lgkmcnt(0)
  v_mfma_f32_32x32x16_bf16 v[108:123], v[88:91], v[216:219], v[108:123]
  v_xor_b32 v126, 16, v125
  v_mul_f32 v92, s72, v92
  v_mul_f32 v93, s72, v93
  v_mul_f32 v94, s72, v94
  v_mul_f32 v95, s72, v95
  v_mul_f32 v96, s72, v96
  v_mul_f32 v97, s72, v97
  v_mul_f32 v98, s72, v98
  v_mul_f32 v99, s72, v99
  v_mul_f32 v100, s72, v100
  v_mul_f32 v101, s72, v101
  v_mul_f32 v102, s72, v102
  v_mul_f32 v103, s72, v103
  v_mul_f32 v104, s72, v104
  v_mul_f32 v105, s72, v105
  v_mul_f32 v106, s72, v106
  v_mul_f32 v107, s72, v107
  v_cvt_pk_bf16_f32 v92, v92, v93
  v_cvt_pk_bf16_f32 v93, v94, v95
  v_cvt_pk_bf16_f32 v94, v96, v97
  v_cvt_pk_bf16_f32 v95, v98, v99
  v_cvt_pk_bf16_f32 v96, v100, v101
  v_cvt_pk_bf16_f32 v97, v102, v103
  v_cvt_pk_bf16_f32 v98, v104, v105
  v_cvt_pk_bf16_f32 v99, v106, v107
  ds_write_b128 v125, v[92:95] offset:0
  ds_write_b128 v126, v[96:99] offset:0
  v_pk_mul_f32 v[108:109], v[108:109], s[72:73] op_sel_hi:[1,0]
  v_pk_mul_f32 v[110:111], v[110:111], s[72:73] op_sel_hi:[1,0]
  v_pk_mul_f32 v[112:113], v[112:113], s[72:73] op_sel_hi:[1,0]
  v_pk_mul_f32 v[114:115], v[114:115], s[72:73] op_sel_hi:[1,0]
  v_pk_mul_f32 v[116:117], v[116:117], s[72:73] op_sel_hi:[1,0]
  v_pk_mul_f32 v[118:119], v[118:119], s[72:73] op_sel_hi:[1,0]
  v_pk_mul_f32 v[120:121], v[120:121], s[72:73] op_sel_hi:[1,0]
  v_pk_mul_f32 v[122:123], v[122:123], s[72:73] op_sel_hi:[1,0]
  v_cvt_pk_bf16_f32 v108, v108, v109
  v_cvt_pk_bf16_f32 v109, v110, v111
  v_cvt_pk_bf16_f32 v110, v112, v113
  v_cvt_pk_bf16_f32 v111, v114, v115
  v_cvt_pk_bf16_f32 v112, v116, v117
  v_cvt_pk_bf16_f32 v113, v118, v119
  v_cvt_pk_bf16_f32 v114, v120, v121
  v_cvt_pk_bf16_f32 v115, v122, v123
  ds_write_b128 v125, v[108:111] offset:16384
  ds_write_b128 v126, v[112:115] offset:16384
  s_branch K_G3
K_G1:
  s_waitcnt lgkmcnt(15)
  v_mfma_f32_32x32x16_bf16 v[92:107], v[60:63], v[220:223], 0
  s_waitcnt lgkmcnt(15)
  v_mfma_f32_32x32x16_bf16 v[92:107], v[64:67], v[224:227], v[92:107]
  s_waitcnt lgkmcnt(15)
  v_mfma_f32_32x32x16_bf16 v[92:107], v[68:71], v[228:231], v[92:107]
  s_waitcnt lgkmcnt(12)
  v_mfma_f32_32x32x16_bf16 v[92:107], v[72:75], v[232:235], v[92:107]
  s_waitcnt lgkmcnt(9)
  v_mfma_f32_32x32x16_bf16 v[92:107], v[76:79], v[236:239], v[92:107]
  s_waitcnt lgkmcnt(6)
  v_mfma_f32_32x32x16_bf16 v[92:107], v[80:83], v[240:243], v[92:107]
  s_waitcnt lgkmcnt(3)
  v_mfma_f32_32x32x16_bf16 v[92:107], v[84:87], v[244:247], v[92:107]
  s_waitcnt lgkmcnt(0)
  v_mfma_f32_32x32x16_bf16 v[92:107], v[88:91], v[248:251], v[92:107]
  v_xor_b32 v126, 16, v125
  s_nop 10
  v_mul_f32 v92, s72, v92
  v_mul_f32 v93, s72, v93
  v_mul_f32 v94, s72, v94
  v_mul_f32 v95, s72, v95
  v_mul_f32 v96, s72, v96
  v_mul_f32 v97, s72, v97
  v_mul_f32 v98, s72, v98
  v_mul_f32 v99, s72, v99
  v_mul_f32 v100, s72, v100
  v_mul_f32 v101, s72, v101
  v_mul_f32 v102, s72, v102
  v_mul_f32 v103, s72, v103
  v_mul_f32 v104, s72, v104
  v_mul_f32 v105, s72, v105
  v_mul_f32 v106, s72, v106
  v_mul_f32 v107, s72, v107
  v_cvt_pk_bf16_f32 v92, v92, v93
  v_cvt_pk_bf16_f32 v93, v94, v95
  v_cvt_pk_bf16_f32 v94, v96, v97
  v_cvt_pk_bf16_f32 v95, v98, v99
  v_cvt_pk_bf16_f32 v96, v100, v101
  v_cvt_pk_bf16_f32 v97, v102, v103
  v_cvt_pk_bf16_f32 v98, v104, v105
  v_cvt_pk_bf16_f32 v99, v106, v107
  ds_write_b128 v125, v[92:95] offset:0
  ds_write_b128 v126, v[96:99] offset:0
K_G3:
  s_waitcnt lgkmcnt(0)
  s_barrier
  ds_read_b128 v[92:95], v11
  ds_read_b128 v[96:99], v11 offset:8192
  ds_read_b128 v[100:103], v11 offset:16384
  s_waitcnt lgkmcnt(2)

  buffer_store_dwordx4 v[92:95], v57, s[24:27], s82 offen sc0 sc1
  s_waitcnt lgkmcnt(1)
  buffer_store_dwordx4 v[96:99], v57, s[24:27], s73 offen sc0 sc1
  s_waitcnt lgkmcnt(0)
  buffer_store_dwordx4 v[100:103], v57, s[24:27], s74 offen sc0 sc1

  s_waitcnt vmcnt(3)
K_COM0:
  s_mul_i32 s22, s52, 21
  s_mul_i32 s23, s62, 40
  s_add_u32 s22, s22, s23
  v_and_b32 v124, 31, v5
  v_add_u32 v124, s22, v124
  v_xor_b32 v125, v124, v58
  v_and_b32 v125, 15, v125
  v_lshl_or_b32 v124, v124, 4, v125
  s_mov_b32 s22, 95488
  v_lshl_add_u32 v124, v124, 4, s22
  v_lshl_add_u32 v126, v58, 11, v53
  v_add_u32 v126, 120064, v126

  s_barrier
  ds_read_b64_tr_b16 v[60:61], v126 offset:0
  ds_read_b64_tr_b16 v[62:63], v126 offset:1024
  ds_read_b128 v[220:223], v124
  ds_read_b64_tr_b16 v[64:65], v126 offset:4096
  ds_read_b64_tr_b16 v[66:67], v126 offset:5120
  v_xor_b32 v125, 32, v124
  ds_read_b128 v[224:227], v125
  ds_read_b64_tr_b16 v[68:69], v126 offset:8192
  ds_read_b64_tr_b16 v[70:71], v126 offset:9216
  v_xor_b32 v125, 64, v124
  ds_read_b128 v[228:231], v125
  ds_read_b64_tr_b16 v[72:73], v126 offset:12288
  ds_read_b64_tr_b16 v[74:75], v126 offset:13312
  v_xor_b32 v125, 96, v124
  ds_read_b128 v[232:235], v125
  ds_read_b64_tr_b16 v[76:77], v126 offset:16384
  ds_read_b64_tr_b16 v[78:79], v126 offset:17408
  v_xor_b32 v125, 128, v124
  ds_read_b128 v[236:239], v125
  ds_read_b64_tr_b16 v[80:81], v126 offset:20480
  ds_read_b64_tr_b16 v[82:83], v126 offset:21504
  v_xor_b32 v125, 160, v124
  ds_read_b128 v[240:243], v125
  ds_read_b64_tr_b16 v[84:85], v126 offset:24576
  ds_read_b64_tr_b16 v[86:87], v126 offset:25600
  v_xor_b32 v125, 192, v124
  ds_read_b128 v[244:247], v125
  ds_read_b64_tr_b16 v[88:89], v126 offset:28672
  ds_read_b64_tr_b16 v[90:91], v126 offset:29696
  v_xor_b32 v125, 224, v124
  ds_read_b128 v[248:251], v125
  ds_read_b64_tr_b16 v[36:37], v126 offset:32768
  ds_read_b64_tr_b16 v[38:39], v126 offset:33792
  s_mul_i32 s22, s3, 3072
  s_add_u32 m0, s22, 17664
  s_brev_b32 s23, 2
  buffer_load_dwordx4 v4, s[24:27], s23 offen lds
  s_add_u32 m0, s22, 42240
  s_cmp_lt_u32 s3, 2
  buffer_load_dwordx4 v4, s[24:27], s23 offen lds
  s_cselect_b32 s79, s22, 69632
  s_add_u32 m0, s22, 66816
  s_lshl_b32 s22, s3, 10
  buffer_load_dwordx4 v4, s[24:27], s23 offen lds

  s_add_u32 m0, s79, 91392
  s_add_u32 s78, s80, 4096
  buffer_load_dwordx4 v4, s[24:27], s23 offen lds
  s_addc_u32 s79, s81, 0
  s_add_u32 m0, s22, 0
  s_cmp_eq_u32 s3, 7
  global_load_lds_dwordx4 v4, s[78:79] offset:1024
  s_cbranch_scc1 L_i7_1

  s_add_u32 m0, s22, 8192
  s_nop 0
  global_load_lds_dwordx4 v4, s[78:79] offset:1024
L_i7_1b:

  s_waitcnt lgkmcnt(15)
  v_mfma_f32_32x32x16_bf16 v[124:139], v[220:223], v[60:63], 0
  v_mov_b64 v[140:141], 0
  s_waitcnt lgkmcnt(15)
  v_mfma_f32_32x32x16_bf16 v[124:139], v[224:227], v[64:67], v[124:139]
  v_mov_b64 v[142:143], 0
  s_waitcnt lgkmcnt(15)
  v_mfma_f32_32x32x16_bf16 v[124:139], v[228:231], v[68:71], v[124:139]
  v_mov_b64 v[144:145], 0
  s_waitcnt lgkmcnt(14)
  v_mfma_f32_32x32x16_bf16 v[124:139], v[232:235], v[72:75], v[124:139]
  v_mov_b64 v[146:147], 0
  s_waitcnt lgkmcnt(11)
  v_mfma_f32_32x32x16_bf16 v[124:139], v[236:239], v[76:79], v[124:139]
  v_mov_b64 v[148:149], 0
  s_waitcnt lgkmcnt(8)
  v_mfma_f32_32x32x16_bf16 v[124:139], v[240:243], v[80:83], v[124:139]
  v_mov_b64 v[150:151], 0
  s_waitcnt lgkmcnt(5)
  v_mfma_f32_32x32x16_bf16 v[124:139], v[244:247], v[84:87], v[124:139]
  v_mov_b64 v[152:153], 0
  s_waitcnt lgkmcnt(2)
  v_mfma_f32_32x32x16_bf16 v[124:139], v[248:251], v[88:91], v[124:139]
  v_mov_b64 v[154:155], 0
  s_mov_b32 s72, 0xbfb8aa3b
  v_cmp_gt_u32 s[36:37], 40, v5
  v_cmp_le_u32 s[38:39], 21, v5
  v_mov_b32 v30, 1.0
  v_mov_b32 v31, 1.0
  s_waitcnt lgkmcnt(0)

  v_lshlrev_b32 v32, 16, v36
  v_and_b32 v33, 0xffff0000, v36
  v_mul_f32 v32, s72, v32
  v_mul_f32 v33, s72, v33
  v_cvt_pk_bf16_f32 v36, v32, v33

  v_lshlrev_b32 v32, 16, v37
  v_and_b32 v33, 0xffff0000, v37
  v_mul_f32 v32, s72, v32
  v_mul_f32 v33, s72, v33
  v_cvt_pk_bf16_f32 v37, v32, v33

  v_lshlrev_b32 v32, 16, v38
  v_and_b32 v33, 0xffff0000, v38
  v_mul_f32 v32, s72, v32
  v_mul_f32 v33, s72, v33
  v_cvt_pk_bf16_f32 v38, v32, v33

  v_lshlrev_b32 v32, 16, v39
  v_and_b32 v33, 0xffff0000, v39
  v_mul_f32 v32, s72, v32
  v_mul_f32 v33, s72, v33
  v_cvt_pk_bf16_f32 v39, v32, v33

K_COMMON:
  v_pk_mul_f32 v[124:125], v[124:125], s[72:73] op_sel_hi:[1,0]
  v_pk_mul_f32 v[126:127], v[126:127], s[72:73] op_sel_hi:[1,0]
  v_pk_mul_f32 v[128:129], v[128:129], s[72:73] op_sel_hi:[1,0]
  v_pk_mul_f32 v[130:131], v[130:131], s[72:73] op_sel_hi:[1,0]
  v_pk_mul_f32 v[132:133], v[132:133], s[72:73] op_sel_hi:[1,0]
  v_pk_mul_f32 v[134:135], v[134:135], s[72:73] op_sel_hi:[1,0]
  v_cvt_pk_bf16_f32 v44, v124, v125
  v_cvt_pk_bf16_f32 v45, v126, v127
  v_cvt_pk_bf16_f32 v42, v128, v129
  v_cvt_pk_bf16_f32 v43, v130, v131
  v_cvt_pk_bf16_f32 v46, v132, v133
  v_cvt_pk_bf16_f32 v47, v134, v135
  s_lshl_b32 s88, s53, 13
  s_add_u32 s88, s88, 7372800

  v_mov_b32 v119, v25
  v_mov_b32 v121, v25
  v_mov_b32 v123, v29
  v_mov_b32 v72, 1
  v_mov_b64 v[92:93], -1
  v_mov_b64 v[94:95], -1
  v_mov_b64 v[96:97], -1
  v_mov_b64 v[98:99], -1

  s_cmp_eq_u32 s62, 0
  s_cbranch_scc1 K2_B3

  s_waitcnt vmcnt(6)
  s_barrier
  s_cmp_eq_u32 s3, 0
  s_cbranch_scc1 K2_B1

K2_B2:
K2_CELLS:
  s_mul_i32 s22, s2, 10240
  s_lshl_b32 s23, s2, 13
  s_add_u32 s23, s23, 2621440
  s_mov_b32 s76, 320000
  v_cmp_gt_u32 s[74:75], s76, v21
  s_and_b32 s72, s74, 0x11111111
  s_and_b32 s73, s75, 0x11111111
  s_mov_b64 s[70:71], s[74:75]

K_POLL:
  s_mov_b64 exec, s[74:75]
  buffer_load_dwordx4 v[92:95], v3, s[40:43], s22 offen sc1
  s_mov_b64 exec, -1
  s_waitcnt vmcnt(0)

  v_bitop3_b32 v80, v92, v93, v94 bitop3:0x96
  v_xor_b32 v80, v80, v95
  s_nop 1
  v_xor_b32_dpp v80, v80, v80 quad_perm:[1,0,3,2] row_mask:0xf bank_mask:0xf
  s_nop 1
  v_xor_b32_dpp v80, v80, v80 quad_perm:[2,3,0,1] row_mask:0xf bank_mask:0xf
  v_xor_b32 v80, s57, v80
  v_cmp_lt_u32 vcc, 1, v80
  s_and_b64 s[74:75], s[74:75], vcc
  s_cbranch_scc1 K_POLL2
  v_cmp_eq_u32 vcc, 1, v80
  s_and_b64 s[76:77], s[70:71], vcc
  s_mov_b64 exec, s[76:77]
  buffer_load_dwordx4 v[96:99], v3, s[24:27], s23 offen sc1
  s_mov_b64 exec, s[72:73]
  v_mov_b32 v92, -1
  s_mov_b64 exec, -1

  s_cmp_lg_u32 s60, 0
  s_barrier
  s_cbranch_scc1 K2_COUNT
  ds_read_b128 v[48:51], v48
  ds_read_b128 v[52:55], v52
K2_COUNT:

  v_cmp_gt_u32 s[66:67], -2, v93
  v_lshrrev_b32 v125, 12, v93
  v_and_b32 v125, 0xfc, v125
  s_mov_b64 exec, s[66:67]
  ds_add_rtn_u32 v101, v125, v72 offset:256
  s_mov_b64 exec, -1
  v_lshrrev_b32 v111, 20, v93
  v_add_u32 v111, v111, v21

  v_cmp_gt_u32 s[64:65], -2, v92
  v_lshrrev_b32 v124, 12, v92
  v_and_b32 v124, 0xfc, v124
  s_mov_b64 exec, s[64:65]
  ds_add_rtn_u32 v100, v124, v72 offset:256
  s_mov_b64 exec, -1
  v_lshrrev_b32 v109, 20, v92
  v_add_u32 v109, v109, v21

  v_cmp_gt_u32 s[68:69], -2, v94
  v_lshrrev_b32 v126, 12, v94
  v_and_b32 v126, 0xfc, v126
  s_mov_b64 exec, s[68:69]
  ds_add_rtn_u32 v102, v126, v72 offset:256
  s_mov_b64 exec, -1
  v_lshrrev_b32 v113, 20, v94
  v_add_u32 v113, v113, v21

  v_cmp_gt_u32 s[70:71], -2, v95
  v_lshrrev_b32 v127, 12, v95
  v_and_b32 v127, 0xfc, v127
  s_mov_b64 exec, s[70:71]
  ds_add_rtn_u32 v103, v127, v72 offset:256
  s_mov_b64 exec, -1
  v_lshrrev_b32 v115, 20, v95
  v_add_u32 v115, v115, v21

  s_cmp_lg_u64 s[76:77], 0
  s_cbranch_scc1 K2_CR
K2_CRB:
  v_subrev_u32 v1, 84, v125
  v_min_u32 v1, v1, v125
  s_mov_b64 exec, s[66:67]
  v_cmpx_gt_u32 vcc, 20, v1
  buffer_load_dword v11, v111, s[32:35], 0 idxen
  s_mov_b64 exec, -1

  v_subrev_u32 v1, 84, v124
  v_min_u32 v1, v1, v124
  s_mov_b64 exec, s[64:65]
  v_cmpx_gt_u32 vcc, 20, v1
  buffer_load_dword v11, v109, s[32:35], 0 idxen
  s_mov_b64 exec, -1

  v_subrev_u32 v1, 84, v126
  v_min_u32 v1, v1, v126
  s_mov_b64 exec, s[68:69]
  v_cmpx_gt_u32 vcc, 20, v1
  buffer_load_dword v11, v113, s[32:35], 0 idxen
  s_mov_b64 exec, -1

  v_subrev_u32 v1, 84, v127
  v_min_u32 v1, v1, v127
  s_mov_b64 exec, s[70:71]
  v_cmpx_gt_u32 vcc, 20, v1
  buffer_load_dword v11, v115, s[32:35], 0 idxen
  s_mov_b64 exec, -1

  v_lshlrev_b32 v1, 2, v5
  v_mov_b32 v2, 1008
  s_mul_i32 s22, s52, 21
  s_add_u32 s22, s22, 8
  s_waitcnt lgkmcnt(0)
  s_barrier

  ds_read_b32 v1, v1 offset:256
  ds_read_b32 v2, v2
  s_waitcnt lgkmcnt(0)
  v_add_u32 v1, 3, v1
  v_and_b32 v1, -4, v1
  v_max_u32 v1, 4, v1
  v_cndmask_b32 v12, 0, v1, s[36:37]
  v_readfirstlane_b32 s23, v2
  s_nop 0
  v_add_u32_dpp v1, v12, v12 row_shr:1 row_mask:0xf bank_mask:0xf bound_ctrl:0
  s_nop 1
  v_add_u32_dpp v1, v1, v1 row_shr:2 row_mask:0xf bank_mask:0xf bound_ctrl:0
  s_nop 1
  v_add_u32_dpp v1, v1, v1 row_shr:4 row_mask:0xf bank_mask:0xf bound_ctrl:0
  s_nop 1
  v_add_u32_dpp v1, v1, v1 row_shr:8 row_mask:0xf bank_mask:0xf bound_ctrl:0
  s_nop 1
  v_add_u32_dpp v1, v1, v1 row_bcast:15 row_mask:0xa bank_mask:0xf
  s_nop 1
  v_add_u32_dpp v1, v1, v1 row_bcast:31 row_mask:0xc bank_mask:0xf
  s_cmp_lg_u32 s23, -1
  s_cbranch_scc1 K2_OVF
  v_readlane_b32 s85, v1, 20
  v_readlane_b32 s86, v1, 39
  v_sub_u32 v12, v1, v12
  s_sub_u32 s23, 896, s85
  v_add_u32 v1, s23, v12
  v_cndmask_b32 v12, v12, v1, s[38:39]
  v_add_u32 v7, v12, v23

  ds_bpermute_b32 v133, v125, v7
  ds_bpermute_b32 v132, v124, v7
  ds_bpermute_b32 v134, v126, v7
  ds_bpermute_b32 v135, v127, v7
  v_readlane_b32 s56, v12, s22
  s_sub_u32 s86, s86, s85
  s_add_u32 s22, s86, 128
  s_max_u32 s22, s85, s22
  s_cmp_gt_u32 s22, 896
  s_cbranch_scc1 K2_OVF
  s_waitcnt lgkmcnt(0)

  s_or_b32 s22, s3, s60
  s_cmp_lg_u32 s22, 0
  s_cbranch_scc1 K2_NRL
  s_buffer_load_dword s55, s[40:43], s87 glc
K2_NRL:

  s_mov_b64 exec, s[66:67]
  v_add_u32_sdwa v101, v133, v101 dst_sel:DWORD dst_unused:UNUSED_PAD src0_sel:WORD_0 src1_sel:DWORD
  v_bfi_b32 v110, s84, v93, v133
  v_lshlrev_b32 v133, 3, v101
  v_lshrrev_b32 v101, 2, v101
  ds_write_b64 v133, v[110:111] offset:1024
  ds_write_b8 v101, v125 offset:512

  s_mov_b64 exec, s[64:65]
  v_add_u32_sdwa v100, v132, v100 dst_sel:DWORD dst_unused:UNUSED_PAD src0_sel:WORD_0 src1_sel:DWORD
  v_bfi_b32 v108, s84, v92, v132
  v_lshlrev_b32 v132, 3, v100
  v_lshrrev_b32 v100, 2, v100
  ds_write_b64 v132, v[108:109] offset:1024
  ds_write_b8 v100, v124 offset:512

  s_mov_b64 exec, s[68:69]
  v_add_u32_sdwa v102, v134, v102 dst_sel:DWORD dst_unused:UNUSED_PAD src0_sel:WORD_0 src1_sel:DWORD
  v_bfi_b32 v112, s84, v94, v134
  v_lshlrev_b32 v134, 3, v102
  v_lshrrev_b32 v102, 2, v102
  ds_write_b64 v134, v[112:113] offset:1024
  ds_write_b8 v102, v126 offset:512

  s_mov_b64 exec, s[70:71]
  v_add_u32_sdwa v103, v135, v103 dst_sel:DWORD dst_unused:UNUSED_PAD src0_sel:WORD_0 src1_sel:DWORD
  v_bfi_b32 v114, s84, v95, v135
  v_lshlrev_b32 v135, 3, v103
  v_lshrrev_b32 v103, 2, v103
  ds_write_b64 v135, v[114:115] offset:1024
  ds_write_b8 v103, v127 offset:512

  s_cmp_lg_u64 s[76:77], 0
  s_cbranch_scc1 K2_SR
K2_SRB:
  s_mov_b64 exec, -1
  s_or_b32 s22, s3, s60
  s_cmp_lg_u32 s22, 0
  s_cbranch_scc1 K2_RDY
  s_waitcnt lgkmcnt(0)
  s_cmp_lg_u32 s55, s57
  s_cbranch_scc1 K2_SPOLL
K2_RDY:
  s_mov_b32 m0, s58
  s_waitcnt lgkmcnt(0)
  s_barrier

K2_START:
  ds_read_u16 v24, v17
  ds_read_u16 v26, v17 offset:64
  ds_read_b32 v28, v19
  ds_read_u8 v1, v0 offset:512
  ds_read_u16 v118, v17 offset:256
  ds_read_u16 v120, v17 offset:320
  ds_read_b32 v122, v19 offset:1024
  ds_read_u8 v68, v18
  ds_read_u8 v12, v18 offset:256
  s_waitcnt lgkmcnt(8)
  buffer_load_dwordx4 v[24:25], s[28:31], 0 idxen offen lds
  s_add_u32 m0, s58, 1024
  s_waitcnt lgkmcnt(7)
  buffer_load_dwordx4 v[26:27], s[28:31], 0 idxen offen lds
  s_cmp_lg_u32 s83, 0
  s_cselect_b32 m0, 161024, s100
  s_waitcnt lgkmcnt(5)
  buffer_load_dwordx4 v[28:29], s[32:35], 0 idxen offen lds
  v_cmp_ne_u32 vcc, 0xff, v1
  v_subrev_u32 v2, 84, v1
  v_min_u32 v1, v1, v2
  v_lshl_add_u32 v2, v1, 3, v22
  v_lshrrev_b32 v1, 1, v1
  v_and_b32 v1, 16, v1
  v_xor_b32 v2, v2, v1
  v_mov_b32 v1, 0x3f80
  s_mov_b64 exec, vcc
  ds_write_b16 v2, v1
  s_mov_b64 exec, -1
  s_add_u32 m0, s58, 2048
  s_waitcnt lgkmcnt(0)
  buffer_load_dwordx4 v[118:119], s[28:31], 0 idxen offen lds
  s_add_u32 m0, s58, 3072
  ds_read_u16 v24, v17 offset:512
  buffer_load_dwordx4 v[120:121], s[28:31], 0 idxen offen lds
  ds_read_u16 v26, v17 offset:576
  ds_read_u16 v118, v17 offset:768
  ds_read_u16 v120, v17 offset:832
  s_cmp_lg_u32 s83, 0
  s_cbranch_scc1 K2_ST2
  s_mul_i32 s22, s52, 896
  s_sub_u32 s56, s56, s22
  s_add_u32 s56, s56, 31
  s_lshr_b32 s56, s56, 5
  s_cmp_eq_u32 s52, 0
  s_cselect_b32 s54, s85, s86
  s_add_u32 s54, s54, 31
  s_lshr_b32 s54, s54, 5
  s_sub_u32 s82, s54, 9
  s_and_b32 s82, s82, -4
  s_add_u32 s82, s82, 1
  s_cmp_lt_u32 s54, 9
  s_cselect_b32 s82, 2147483647, s82
  s_cmp_lg_u32 s60, 0
  s_cselect_b32 s82, 2147483647, s82
  s_sub_u32 s86, s54, 1
  s_min_u32 s85, s86, s82
K2_ST2:
  s_sub_u32 s22, s54, 1
  s_lshr_b32 s22, s22, 1
  s_mul_i32 s22, s22, 3072
  s_add_u32 s22, s22, 5120
  v_add_u32 v15, s22, v16
  s_add_u32 s59, s100, 6144
  s_mov_b32 s55, 0
  v_mov_b32 v8, 1
  v_mov_b64 v[40:41], v[44:45]
  v_mov_b64 v[80:81], 0
  v_mov_b64 v[82:83], 0
  v_mov_b64 v[84:85], v[30:31]
  v_mov_b64 v[86:87], v[30:31]
  v_mov_b64 v[76:77], 0
  v_mov_b64 v[72:73], 0
  v_mov_b64 v[74:75], 0
  v_mov_b64 v[32:33], 0
  s_cmp_lg_u32 s83, 0
  s_waitcnt vmcnt(2) lgkmcnt(0)
  s_cbranch_scc1 K2_GO
  s_barrier
K2_GO:
  s_or_b32 s22, s60, s83

  ds_read_b128 v[60:63], v68
  ds_read_b128 v[56:59], v16 offset:3072
  ds_read_b128 v[64:67], v20
  ds_read_b128 v[68:71], v13
  s_cbranch_scc1 K2_SAFEP

  s_waitcnt lgkmcnt(0)
  v_mfma_f32_32x32x16_bf16 v[92:107], v[56:59], v[36:39], 0
  ds_read_b128 v[56:59], v16 offset:4096
  v_mfma_f32_32x32x16_bf16 v[92:107], v[60:63], v[40:43], v[92:107]
  ds_read_b128 v[60:63], v12
  ds_read_u8 v12, v18 offset:512
  v_mfma_f32_32x32x16_bf16 v[92:107], v[64:67], v[48:51], v[92:107]
  s_cmp_lt_u32 s59, s63
  s_cselect_b32 s23, s59, 161024
  s_add_u32 s59, s59, 6144
  v_mfma_f32_32x32x16_bf16 v[92:107], v[68:71], v[52:55], v[92:107]
  s_setprio 0
  s_add_u32 m0, s58, 4096
  s_nop 0
  buffer_load_dwordx4 v[24:25], s[28:31], 0 idxen offen lds
  s_add_u32 m0, s58, 5120
  ds_read_u16 v24, v17 offset:1024
  buffer_load_dwordx4 v[26:27], s[28:31], 0 idxen offen lds

  v_mov_b32 v28, v122
  s_add_u32 m0, s58, 6144
  ds_read_u16 v26, v17 offset:1088
  buffer_load_dwordx4 v[118:119], s[28:31], 0 idxen offen lds
  s_add_u32 m0, s58, 7168
  s_nop 0
  buffer_load_dwordx4 v[120:121], s[28:31], 0 idxen offen lds

  s_mov_b32 m0, s23
  s_waitcnt vmcnt(4) lgkmcnt(0)
  buffer_load_dwordx4 v[28:29], s[32:35], 0 idxen offen lds
  s_add_u32 m0, s58, 0
  ds_read_b128 v[64:67], v20 offset:2048
  buffer_load_dwordx4 v[24:25], s[28:31], 0 idxen offen lds
  s_add_u32 m0, s58, 1024
  ds_read_b128 v[68:71], v13 offset:2048
  buffer_load_dwordx4 v[26:27], s[28:31], 0 idxen offen lds
  ds_read_u16 v24, v17 offset:1280
  ds_read_u16 v26, v17 offset:1344
  s_nop 0
K2_LOOP:
  .p2align 3
  v_exp_f32 v124, v92
  v_exp_f32 v125, v93
  v_exp_f32 v132, v100
  v_exp_f32 v133, v101
  v_exp_f32 v126, v94
  v_exp_f32 v127, v95
  v_exp_f32 v134, v102
  v_exp_f32 v135, v103
  v_exp_f32 v128, v96
  v_exp_f32 v129, v97
  v_exp_f32 v136, v104
  v_exp_f32 v137, v105
  v_exp_f32 v130, v98
  v_exp_f32 v131, v99
  v_exp_f32 v138, v106
  v_exp_f32 v139, v107
  v_rcp_f32 v88, v84
  v_rcp_f32 v89, v85
  v_rcp_f32 v90, v86
  v_rcp_f32 v91, v87
  v_add_u32 v8, 1, v8
  s_setprio 1
  v_pk_fma_f32 v[32:33], v[84:85], v[86:87], v[32:33]
  v_pk_mul_f32 v[80:81], v[80:81], v[88:89]
  v_pk_mul_f32 v[82:83], v[82:83], v[90:91]
  v_cvt_pk_bf16_f32 v78, v80, v81
  v_cvt_pk_bf16_f32 v79, v82, v83
  v_pk_add_f32 v[124:125], v[124:125], v[30:31]
  v_pk_add_f32 v[132:133], v[132:133], v[30:31]
  v_pk_fma_f32 v[92:93], v[92:93], v[126:127], v[92:93]
  v_pk_fma_f32 v[100:101], v[100:101], v[134:135], v[100:101]
  v_pk_fma_f32 v[92:93], v[94:95], v[124:125], v[92:93]
  v_pk_fma_f32 v[100:101], v[102:103], v[132:133], v[100:101]
  v_pk_fma_f32 v[124:125], v[124:125], v[126:127], v[124:125]
  v_pk_fma_f32 v[132:133], v[132:133], v[134:135], v[132:133]
  v_pk_fma_f32 v[92:93], v[92:93], v[128:129], v[92:93]
  v_pk_fma_f32 v[100:101], v[100:101], v[136:137], v[100:101]
  v_pk_fma_f32 v[92:93], v[96:97], v[124:125], v[92:93]
  v_pk_fma_f32 v[100:101], v[104:105], v[132:133], v[100:101]
  v_pk_fma_f32 v[124:125], v[124:125], v[128:129], v[124:125]
  v_pk_fma_f32 v[132:133], v[132:133], v[136:137], v[132:133]
  v_pk_fma_f32 v[92:93], v[92:93], v[130:131], v[92:93]
  v_pk_fma_f32 v[100:101], v[100:101], v[138:139], v[100:101]
  v_pk_fma_f32 v[80:81], v[98:99], v[124:125], v[92:93]
  v_pk_fma_f32 v[82:83], v[106:107], v[132:133], v[100:101]
  v_pk_fma_f32 v[84:85], v[124:125], v[130:131], v[124:125]
  v_pk_fma_f32 v[86:87], v[132:133], v[138:139], v[132:133]
  s_setprio 2
  s_waitcnt lgkmcnt(0)
  v_mfma_f32_32x32x16_bf16 v[140:155], v[76:79], v[72:75], v[140:155]
  s_add_u32 s55, s55, 1
  s_cmp_eq_u32 s55, s56
  s_cbranch_scc1 L_sw_2
L_swb_3:
  v_mfma_f32_32x32x16_bf16 v[92:107], v[56:59], v[36:39], 0
  ds_read_b128 v[56:59], v16 offset:6144
  v_mfma_f32_32x32x16_bf16 v[92:107], v[60:63], v[40:43], v[92:107]
  ds_read_b128 v[60:63], v12
  ds_read_u8 v12, v18 offset:768
  v_mfma_f32_32x32x16_bf16 v[92:107], v[64:67], v[48:51], v[92:107]
  s_add_u32 m0, s58, 2048
  v_mfma_f32_32x32x16_bf16 v[92:107], v[68:71], v[52:55], v[92:107]
  s_setprio 0
  s_waitcnt vmcnt(5)
  ds_read_b128 v[64:67], v20 offset:4096
  buffer_load_dwordx4 v[24:25], s[28:31], 0 idxen offen lds
  s_add_u32 m0, s58, 3072
  ds_read_b128 v[68:71], v13 offset:4096
  buffer_load_dwordx4 v[26:27], s[28:31], 0 idxen offen lds
  ds_read_u16 v24, v17 offset:1536
  ds_read_u16 v26, v17 offset:1600
  s_nop 0
  s_cmp_ge_u32 s55, s85
  s_cbranch_scc1 L_uv_4
L_vb_5:
  .p2align 3
  s_nop 0
  v_exp_f32 v124, v92
  v_exp_f32 v125, v93
  v_exp_f32 v132, v100
  v_exp_f32 v133, v101
  v_exp_f32 v126, v94
  v_exp_f32 v127, v95
  v_exp_f32 v134, v102
  v_exp_f32 v135, v103
  v_exp_f32 v128, v96
  v_exp_f32 v129, v97
  v_exp_f32 v136, v104
  v_exp_f32 v137, v105
  v_exp_f32 v130, v98
  v_exp_f32 v131, v99
  v_exp_f32 v138, v106
  v_exp_f32 v139, v107
  v_rcp_f32 v88, v84
  v_rcp_f32 v89, v85
  v_rcp_f32 v90, v86
  v_rcp_f32 v91, v87
  s_setprio 1
  v_pk_fma_f32 v[32:33], v[84:85], v[86:87], v[32:33]
  v_pk_mul_f32 v[80:81], v[80:81], v[88:89]
  v_pk_mul_f32 v[82:83], v[82:83], v[90:91]
  v_cvt_pk_bf16_f32 v76, v80, v81
  v_cvt_pk_bf16_f32 v77, v82, v83
  v_pk_add_f32 v[124:125], v[124:125], v[30:31]
  v_pk_add_f32 v[132:133], v[132:133], v[30:31]
  v_pk_fma_f32 v[92:93], v[92:93], v[126:127], v[92:93]
  v_pk_fma_f32 v[100:101], v[100:101], v[134:135], v[100:101]
  v_pk_fma_f32 v[92:93], v[94:95], v[124:125], v[92:93]
  v_pk_fma_f32 v[100:101], v[102:103], v[132:133], v[100:101]
  v_pk_fma_f32 v[124:125], v[124:125], v[126:127], v[124:125]
  v_pk_fma_f32 v[132:133], v[132:133], v[134:135], v[132:133]
  v_pk_fma_f32 v[92:93], v[92:93], v[128:129], v[92:93]
  v_pk_fma_f32 v[100:101], v[100:101], v[136:137], v[100:101]
  v_pk_fma_f32 v[92:93], v[96:97], v[124:125], v[92:93]
  v_pk_fma_f32 v[100:101], v[104:105], v[132:133], v[100:101]
  v_pk_fma_f32 v[124:125], v[124:125], v[128:129], v[124:125]
  v_pk_fma_f32 v[132:133], v[132:133], v[136:137], v[132:133]
  v_pk_fma_f32 v[92:93], v[92:93], v[130:131], v[92:93]
  v_pk_fma_f32 v[100:101], v[100:101], v[138:139], v[100:101]
  v_pk_fma_f32 v[80:81], v[98:99], v[124:125], v[92:93]
  v_pk_fma_f32 v[82:83], v[106:107], v[132:133], v[100:101]
  v_pk_fma_f32 v[84:85], v[124:125], v[130:131], v[124:125]
  v_pk_fma_f32 v[86:87], v[132:133], v[138:139], v[132:133]
  s_setprio 2
  s_waitcnt lgkmcnt(0)
  v_mfma_f32_32x32x16_bf16 v[92:107], v[56:59], v[36:39], 0
  s_add_u32 s55, s55, 1
  s_cmp_eq_u32 s55, s56
  s_cbranch_scc1 L_sw_6
L_swb_7:
  ds_read_b128 v[56:59], v16 offset:7168
  v_mfma_f32_32x32x16_bf16 v[92:107], v[60:63], v[40:43], v[92:107]
  ds_read_b128 v[60:63], v12
  ds_read_u8 v12, v18 offset:1024
  ds_read_b128 v[72:75], v16 offset:5120
  v_mfma_f32_32x32x16_bf16 v[92:107], v[64:67], v[48:51], v[92:107]
  s_add_u32 m0, s58, 4096
  v_mfma_f32_32x32x16_bf16 v[92:107], v[68:71], v[52:55], v[92:107]
  s_setprio 0
  s_waitcnt vmcnt(2)
  ds_read_b128 v[64:67], v20 offset:6144
  buffer_load_dwordx4 v[24:25], s[28:31], 0 idxen offen lds
  s_add_u32 m0, s58, 5120
  ds_read_b128 v[68:71], v13 offset:6144
  buffer_load_dwordx4 v[26:27], s[28:31], 0 idxen offen lds
  ds_read_u16 v24, v17 offset:1792
  ds_read_u16 v26, v17 offset:1856
  s_mov_b64 exec, 1
  ds_write_b32 v6, v8
  s_mov_b64 exec, -1
  s_cmp_ge_u32 s55, s85
  s_cbranch_scc1 L_uv_9
L_vb_10:
  .p2align 3
  s_nop 0
  v_exp_f32 v124, v92
  v_exp_f32 v125, v93
  v_exp_f32 v132, v100
  v_exp_f32 v133, v101
  v_exp_f32 v126, v94
  v_exp_f32 v127, v95
  v_exp_f32 v134, v102
  v_exp_f32 v135, v103
  v_exp_f32 v128, v96
  v_exp_f32 v129, v97
  v_exp_f32 v136, v104
  v_exp_f32 v137, v105
  v_exp_f32 v130, v98
  v_exp_f32 v131, v99
  v_exp_f32 v138, v106
  v_exp_f32 v139, v107
  v_rcp_f32 v88, v84
  v_rcp_f32 v89, v85
  v_rcp_f32 v90, v86
  v_rcp_f32 v91, v87
  s_setprio 1
  v_pk_fma_f32 v[32:33], v[84:85], v[86:87], v[32:33]
  v_pk_mul_f32 v[80:81], v[80:81], v[88:89]
  v_pk_mul_f32 v[82:83], v[82:83], v[90:91]
  v_cvt_pk_bf16_f32 v78, v80, v81
  v_cvt_pk_bf16_f32 v79, v82, v83
  v_pk_add_f32 v[124:125], v[124:125], v[30:31]
  v_pk_add_f32 v[132:133], v[132:133], v[30:31]
  v_pk_fma_f32 v[92:93], v[92:93], v[126:127], v[92:93]
  v_pk_fma_f32 v[100:101], v[100:101], v[134:135], v[100:101]
  v_pk_fma_f32 v[92:93], v[94:95], v[124:125], v[92:93]
  v_pk_fma_f32 v[100:101], v[102:103], v[132:133], v[100:101]
  v_pk_fma_f32 v[124:125], v[124:125], v[126:127], v[124:125]
  v_pk_fma_f32 v[132:133], v[132:133], v[134:135], v[132:133]
  v_pk_fma_f32 v[92:93], v[92:93], v[128:129], v[92:93]
  v_pk_fma_f32 v[100:101], v[100:101], v[136:137], v[100:101]
  v_pk_fma_f32 v[92:93], v[96:97], v[124:125], v[92:93]
  v_pk_fma_f32 v[100:101], v[104:105], v[132:133], v[100:101]
  v_pk_fma_f32 v[124:125], v[124:125], v[128:129], v[124:125]
  v_pk_fma_f32 v[132:133], v[132:133], v[136:137], v[132:133]
  v_pk_fma_f32 v[92:93], v[92:93], v[130:131], v[92:93]
  v_pk_fma_f32 v[100:101], v[100:101], v[138:139], v[100:101]
  v_pk_fma_f32 v[80:81], v[98:99], v[124:125], v[92:93]
  v_pk_fma_f32 v[82:83], v[106:107], v[132:133], v[100:101]
  v_pk_fma_f32 v[84:85], v[124:125], v[130:131], v[124:125]
  v_pk_fma_f32 v[86:87], v[132:133], v[138:139], v[132:133]
  s_setprio 2
  s_waitcnt lgkmcnt(0)
  v_mfma_f32_32x32x16_bf16 v[140:155], v[76:79], v[72:75], v[140:155]
  ds_read_b32 v7, v14
  s_add_u32 s55, s55, 1
  s_cmp_eq_u32 s55, s56
  s_cbranch_scc1 L_sw_11
L_swb_12:
  v_mfma_f32_32x32x16_bf16 v[92:107], v[56:59], v[36:39], 0
  ds_read_b32 v28, v19 offset:2048
  v_mfma_f32_32x32x16_bf16 v[92:107], v[60:63], v[40:43], v[92:107]
  ds_read_b128 v[60:63], v12
  ds_read_u8 v12, v18 offset:1280
  v_mfma_f32_32x32x16_bf16 v[92:107], v[64:67], v[48:51], v[92:107]
  s_waitcnt lgkmcnt(3)
  v_cmp_gt_u32 vcc, v8, v7
  s_add_u32 m0, s58, 6144
  v_mfma_f32_32x32x16_bf16 v[92:107], v[68:71], v[52:55], v[92:107]
  s_setprio 0
  s_cbranch_vccnz L_fw_13
L_fb_14:
  ds_read_b128 v[56:59], v16 offset:9216
  s_waitcnt vmcnt(4)
  ds_read_b128 v[64:67], v20 offset:0
  buffer_load_dwordx4 v[24:25], s[28:31], 0 idxen offen lds
  s_add_u32 m0, s58, 7168
  ds_read_b128 v[68:71], v13 offset:0
  buffer_load_dwordx4 v[26:27], s[28:31], 0 idxen offen lds
  ds_read_u16 v24, v17 offset:2048
  ds_read_u16 v26, v17 offset:2112
  s_cmp_ge_u32 s55, s85
  s_cbranch_scc1 L_uv_15
L_vb_16:
  .p2align 3
  s_nop 0
  v_exp_f32 v124, v92
  v_exp_f32 v125, v93
  v_exp_f32 v132, v100
  v_exp_f32 v133, v101
  v_exp_f32 v126, v94
  v_exp_f32 v127, v95
  v_exp_f32 v134, v102
  v_exp_f32 v135, v103
  v_exp_f32 v128, v96
  v_exp_f32 v129, v97
  v_exp_f32 v136, v104
  v_exp_f32 v137, v105
  v_exp_f32 v130, v98
  v_exp_f32 v131, v99
  v_exp_f32 v138, v106
  v_exp_f32 v139, v107
  v_rcp_f32 v88, v84
  v_rcp_f32 v89, v85
  v_rcp_f32 v90, v86
  v_rcp_f32 v91, v87
  v_add_u32 v16, 6144, v16
  v_add_u32 v17, 1024, v17
  v_add_u32 v18, 1024, v18
  v_add_u32 v19, 1024, v19
  s_setprio 1
  v_pk_fma_f32 v[32:33], v[84:85], v[86:87], v[32:33]
  v_pk_mul_f32 v[80:81], v[80:81], v[88:89]
  v_pk_mul_f32 v[82:83], v[82:83], v[90:91]
  v_cvt_pk_bf16_f32 v76, v80, v81
  v_cvt_pk_bf16_f32 v77, v82, v83
  v_pk_add_f32 v[124:125], v[124:125], v[30:31]
  v_pk_add_f32 v[132:133], v[132:133], v[30:31]
  v_pk_fma_f32 v[92:93], v[92:93], v[126:127], v[92:93]
  v_pk_fma_f32 v[100:101], v[100:101], v[134:135], v[100:101]
  v_pk_fma_f32 v[92:93], v[94:95], v[124:125], v[92:93]
  v_pk_fma_f32 v[100:101], v[102:103], v[132:133], v[100:101]
  v_pk_fma_f32 v[124:125], v[124:125], v[126:127], v[124:125]
  v_pk_fma_f32 v[132:133], v[132:133], v[134:135], v[132:133]
  v_pk_fma_f32 v[92:93], v[92:93], v[128:129], v[92:93]
  v_pk_fma_f32 v[100:101], v[100:101], v[136:137], v[100:101]
  v_pk_fma_f32 v[92:93], v[96:97], v[124:125], v[92:93]
  v_pk_fma_f32 v[100:101], v[104:105], v[132:133], v[100:101]
  v_pk_fma_f32 v[124:125], v[124:125], v[128:129], v[124:125]
  v_pk_fma_f32 v[132:133], v[132:133], v[136:137], v[132:133]
  v_pk_fma_f32 v[92:93], v[92:93], v[130:131], v[92:93]
  v_pk_fma_f32 v[100:101], v[100:101], v[138:139], v[100:101]
  v_pk_fma_f32 v[80:81], v[98:99], v[124:125], v[92:93]
  v_pk_fma_f32 v[82:83], v[106:107], v[132:133], v[100:101]
  v_pk_fma_f32 v[84:85], v[124:125], v[130:131], v[124:125]
  v_pk_fma_f32 v[86:87], v[132:133], v[138:139], v[132:133]
  s_setprio 2
  s_waitcnt lgkmcnt(0)
  v_mfma_f32_32x32x16_bf16 v[92:107], v[56:59], v[36:39], 0
  s_add_u32 s55, s55, 1
  s_cmp_eq_u32 s55, s56
  s_cbranch_scc1 L_sw_17
L_swb_18:
  ds_read_b128 v[56:59], v16 offset:4096
  v_mfma_f32_32x32x16_bf16 v[92:107], v[60:63], v[40:43], v[92:107]
  ds_read_b128 v[60:63], v12
  ds_read_u8 v12, v18 offset:512
  ds_read_b128 v[72:75], v16 offset:2048
  v_mfma_f32_32x32x16_bf16 v[92:107], v[64:67], v[48:51], v[92:107]
  s_cmp_lt_u32 s59, s63
  s_cselect_b32 m0, s59, 161024
  s_add_u32 s59, s59, 6144
  v_mfma_f32_32x32x16_bf16 v[92:107], v[68:71], v[52:55], v[92:107]
  s_setprio 0
  s_waitcnt vmcnt(4)
  buffer_load_dwordx4 v[28:29], s[32:35], 0 idxen offen lds
  s_add_u32 m0, s58, 0
  ds_read_b128 v[64:67], v20 offset:2048
  buffer_load_dwordx4 v[24:25], s[28:31], 0 idxen offen lds
  s_add_u32 m0, s58, 1024
  ds_read_b128 v[68:71], v13 offset:2048
  buffer_load_dwordx4 v[26:27], s[28:31], 0 idxen offen lds
  ds_read_u16 v24, v17 offset:1280
  ds_read_u16 v26, v17 offset:1344
  s_cmp_ge_u32 s55, s85
  s_cbranch_scc1 L_uv_19
L_vb_20:
  s_branch K2_LOOP
K2_LAST0:
  .p2align 3
  s_nop 0
  v_mfma_f32_32x32x16_bf16 v[108:123], v[156:159], v[220:223], 0
  v_exp_f32 v124, v92
  v_exp_f32 v125, v93
  v_exp_f32 v132, v100
  v_mfma_f32_32x32x16_bf16 v[108:123], v[160:163], v[224:227], v[108:123]
  v_exp_f32 v133, v101
  v_exp_f32 v126, v94
  v_exp_f32 v127, v95
  v_mfma_f32_32x32x16_bf16 v[108:123], v[164:167], v[228:231], v[108:123]
  v_exp_f32 v134, v102
  v_exp_f32 v135, v103
  v_exp_f32 v128, v96
  v_mfma_f32_32x32x16_bf16 v[108:123], v[168:171], v[232:235], v[108:123]
  v_exp_f32 v129, v97
  v_exp_f32 v136, v104
  v_exp_f32 v137, v105
  v_mfma_f32_32x32x16_bf16 v[108:123], v[172:175], v[236:239], v[108:123]
  v_exp_f32 v130, v98
  v_exp_f32 v131, v99
  v_exp_f32 v138, v106
  v_mfma_f32_32x32x16_bf16 v[108:123], v[176:179], v[240:243], v[108:123]
  v_exp_f32 v139, v107
  v_rcp_f32 v88, v84
  v_rcp_f32 v89, v85
  v_rcp_f32 v90, v86
  v_rcp_f32 v91, v87
  s_setprio 1
  v_pk_fma_f32 v[32:33], v[84:85], v[86:87], v[32:33]
  v_pk_mul_f32 v[80:81], v[80:81], v[88:89]
  v_pk_mul_f32 v[82:83], v[82:83], v[90:91]
  v_cvt_pk_bf16_f32 v78, v80, v81
  v_cvt_pk_bf16_f32 v79, v82, v83
  v_pk_add_f32 v[124:125], v[124:125], v[30:31]
  v_pk_add_f32 v[132:133], v[132:133], v[30:31]
  v_pk_fma_f32 v[92:93], v[92:93], v[126:127], v[92:93]
  v_pk_fma_f32 v[100:101], v[100:101], v[134:135], v[100:101]
  v_pk_fma_f32 v[92:93], v[94:95], v[124:125], v[92:93]
  v_pk_fma_f32 v[100:101], v[102:103], v[132:133], v[100:101]
  v_pk_fma_f32 v[124:125], v[124:125], v[126:127], v[124:125]
  v_pk_fma_f32 v[132:133], v[132:133], v[134:135], v[132:133]
  v_pk_fma_f32 v[92:93], v[92:93], v[128:129], v[92:93]
  v_pk_fma_f32 v[100:101], v[100:101], v[136:137], v[100:101]
  v_pk_fma_f32 v[92:93], v[96:97], v[124:125], v[92:93]
  v_pk_fma_f32 v[100:101], v[104:105], v[132:133], v[100:101]
  v_pk_fma_f32 v[124:125], v[124:125], v[128:129], v[124:125]
  v_pk_fma_f32 v[132:133], v[132:133], v[136:137], v[132:133]
  v_pk_fma_f32 v[92:93], v[92:93], v[130:131], v[92:93]
  v_pk_fma_f32 v[100:101], v[100:101], v[138:139], v[100:101]
  v_pk_fma_f32 v[80:81], v[98:99], v[124:125], v[92:93]
  v_pk_fma_f32 v[82:83], v[106:107], v[132:133], v[100:101]
  v_pk_fma_f32 v[84:85], v[124:125], v[130:131], v[124:125]
  v_pk_fma_f32 v[86:87], v[132:133], v[138:139], v[132:133]
  s_branch K2_EXIT
K2_LAST1:
  .p2align 3
  s_nop 0
  v_mfma_f32_32x32x16_bf16 v[108:123], v[156:159], v[220:223], 0
  v_exp_f32 v124, v92
  v_exp_f32 v125, v93
  v_exp_f32 v132, v100
  v_mfma_f32_32x32x16_bf16 v[108:123], v[160:163], v[224:227], v[108:123]
  v_exp_f32 v133, v101
  v_exp_f32 v126, v94
  v_exp_f32 v127, v95
  v_mfma_f32_32x32x16_bf16 v[108:123], v[164:167], v[228:231], v[108:123]
  v_exp_f32 v134, v102
  v_exp_f32 v135, v103
  v_exp_f32 v128, v96
  v_mfma_f32_32x32x16_bf16 v[108:123], v[168:171], v[232:235], v[108:123]
  v_exp_f32 v129, v97
  v_exp_f32 v136, v104
  v_exp_f32 v137, v105
  v_mfma_f32_32x32x16_bf16 v[108:123], v[172:175], v[236:239], v[108:123]
  v_exp_f32 v130, v98
  v_exp_f32 v131, v99
  v_exp_f32 v138, v106
  v_mfma_f32_32x32x16_bf16 v[108:123], v[176:179], v[240:243], v[108:123]
  v_exp_f32 v139, v107
  v_rcp_f32 v88, v84
  v_rcp_f32 v89, v85
  v_rcp_f32 v90, v86
  v_rcp_f32 v91, v87
  s_setprio 1
  v_pk_fma_f32 v[32:33], v[84:85], v[86:87], v[32:33]
  v_pk_mul_f32 v[80:81], v[80:81], v[88:89]
  v_pk_mul_f32 v[82:83], v[82:83], v[90:91]
  v_cvt_pk_bf16_f32 v76, v80, v81
  v_cvt_pk_bf16_f32 v77, v82, v83
  v_pk_add_f32 v[124:125], v[124:125], v[30:31]
  v_pk_add_f32 v[132:133], v[132:133], v[30:31]
  v_pk_fma_f32 v[92:93], v[92:93], v[126:127], v[92:93]
  v_pk_fma_f32 v[100:101], v[100:101], v[134:135], v[100:101]
  v_pk_fma_f32 v[92:93], v[94:95], v[124:125], v[92:93]
  v_pk_fma_f32 v[100:101], v[102:103], v[132:133], v[100:101]
  v_pk_fma_f32 v[124:125], v[124:125], v[126:127], v[124:125]
  v_pk_fma_f32 v[132:133], v[132:133], v[134:135], v[132:133]
  v_pk_fma_f32 v[92:93], v[92:93], v[128:129], v[92:93]
  v_pk_fma_f32 v[100:101], v[100:101], v[136:137], v[100:101]
  v_pk_fma_f32 v[92:93], v[96:97], v[124:125], v[92:93]
  v_pk_fma_f32 v[100:101], v[104:105], v[132:133], v[100:101]
  v_pk_fma_f32 v[124:125], v[124:125], v[128:129], v[124:125]
  v_pk_fma_f32 v[132:133], v[132:133], v[136:137], v[132:133]
  v_pk_fma_f32 v[92:93], v[92:93], v[130:131], v[92:93]
  v_pk_fma_f32 v[100:101], v[100:101], v[138:139], v[100:101]
  v_pk_fma_f32 v[80:81], v[98:99], v[124:125], v[92:93]
  v_pk_fma_f32 v[82:83], v[106:107], v[132:133], v[100:101]
  v_pk_fma_f32 v[84:85], v[124:125], v[130:131], v[124:125]
  v_pk_fma_f32 v[86:87], v[132:133], v[138:139], v[132:133]
K2_EXIT:
  s_setprio 0
  ds_read_b128 v[60:63], v15
  v_mfma_f32_32x32x16_bf16 v[108:123], v[180:183], v[244:247], v[108:123]
  v_rcp_f32 v88, v84
  v_rcp_f32 v89, v85
  v_rcp_f32 v90, v86
  v_rcp_f32 v91, v87
  v_mfma_f32_32x32x16_bf16 v[108:123], v[184:187], v[248:251], v[108:123]
  v_fma_f32 v32, v84, v86, v32
  v_fma_f32 v33, v85, v87, v33
  v_mul_f32 v80, v80, v88
  v_mul_f32 v81, v81, v89
  v_mul_f32 v82, v82, v90
  v_mul_f32 v83, v83, v91
K2_X2:
  s_bitcmp1_b32 s54, 0
  s_cbranch_scc0 K2_X3
  s_waitcnt lgkmcnt(1)
  v_mfma_f32_32x32x16_bf16 v[140:155], v[76:79], v[72:75], v[140:155]
  v_cvt_pk_bf16_f32 v76, v80, v81
  v_cvt_pk_bf16_f32 v77, v82, v83
  s_branch K2_X4
K2_X3:
  v_cvt_pk_bf16_f32 v78, v80, v81
  v_cvt_pk_bf16_f32 v79, v82, v83
K2_X4:
  v_max_f32 v32, v32, v33
  s_waitcnt lgkmcnt(0)
  v_mfma_f32_32x32x16_bf16 v[140:155], v[76:79], v[60:63], v[140:155]
  v_add_u32 v1, s58, v4
  s_cmp_eq_u32 s60, 1
  s_cbranch_scc1 K2_NEXTR
K2_FIN:
  s_cmp_eq_u32 s82, 2147483647
  s_cbranch_scc1 K2_ULD
K2_ULB:
  s_mov_b32 s22, 0xbf317218
  s_mov_b32 s23, 0x5d800000
  v_mov_b64 v[80:81], 0
  v_mov_b32 v33, 0
  s_lshl_b32 s76, s52, 15
  s_add_u32 s76, s76, 95488
  v_add_u32 v2, s76, v4

  v_pk_mul_f32 v[140:141], v[140:141], s[22:23] op_sel_hi:[1,0]
  v_pk_mul_f32 v[142:143], v[142:143], s[22:23] op_sel_hi:[1,0]
  v_pk_mul_f32 v[144:145], v[144:145], s[22:23] op_sel_hi:[1,0]
  v_pk_mul_f32 v[146:147], v[146:147], s[22:23] op_sel_hi:[1,0]
  v_pk_mul_f32 v[148:149], v[148:149], s[22:23] op_sel_hi:[1,0]
  v_pk_mul_f32 v[150:151], v[150:151], s[22:23] op_sel_hi:[1,0]
  v_pk_mul_f32 v[152:153], v[152:153], s[22:23] op_sel_hi:[1,0]
  v_pk_mul_f32 v[154:155], v[154:155], s[22:23] op_sel_hi:[1,0]
  v_cvt_pk_bf16_f32 v124, v140, v141
  v_cvt_pk_bf16_f32 v125, v142, v143
  v_cvt_pk_bf16_f32 v126, v144, v145
  v_cvt_pk_bf16_f32 v127, v146, v147
  v_cvt_pk_bf16_f32 v128, v148, v149
  v_cvt_pk_bf16_f32 v129, v150, v151
  v_cvt_pk_bf16_f32 v130, v152, v153
  v_cvt_pk_bf16_f32 v131, v154, v155
  v_pk_fma_f32 v[32:33], v[140:141], v[80:81], v[32:33]
  v_pk_fma_f32 v[32:33], v[142:143], v[80:81], v[32:33]
  v_pk_fma_f32 v[32:33], v[144:145], v[80:81], v[32:33]
  v_pk_fma_f32 v[32:33], v[146:147], v[80:81], v[32:33]
  v_pk_fma_f32 v[32:33], v[148:149], v[80:81], v[32:33]
  v_pk_fma_f32 v[32:33], v[150:151], v[80:81], v[32:33]
  v_pk_fma_f32 v[32:33], v[152:153], v[80:81], v[32:33]
  v_pk_fma_f32 v[32:33], v[154:155], v[80:81], v[32:33]
  v_add_f32 v32, v32, v33
  v_cmp_nge_f32 vcc, s23, v32
  s_cbranch_vccnz K2_TRIP
K2_TRB:
  s_waitcnt vmcnt(0)
  ds_write_b128 v1, v[124:127]
  ds_write_b128 v1, v[128:131] offset:1024
  v_mov_b32 v8, 0x7fff

  s_waitcnt lgkmcnt(0)
  s_mov_b64 exec, 1
  ds_write_b32 v6, v8
  s_mov_b64 exec, -1
  ds_read_b32 v7, v14
K2_GS:
  s_waitcnt lgkmcnt(0)
  v_cmp_gt_u32 vcc, v8, v7
  s_cbranch_vccnz K2_GS2

  ds_read_b128 v[220:223], v2 offset:0
  ds_read_b128 v[224:227], v2 offset:1024
  ds_read_b128 v[228:231], v2 offset:8192
  ds_read_b128 v[232:235], v2 offset:9216
  ds_read_b128 v[236:239], v2 offset:16384
  ds_read_b128 v[240:243], v2 offset:17408
  ds_read_b128 v[244:247], v2 offset:24576
  ds_read_b128 v[248:251], v2 offset:25600
  s_waitcnt lgkmcnt(7)
  v_mfma_f32_32x32x16_bf16 v[108:123], v[188:191], v[220:223], v[108:123]
  s_waitcnt lgkmcnt(6)
  v_mfma_f32_32x32x16_bf16 v[108:123], v[192:195], v[224:227], v[108:123]
  s_waitcnt lgkmcnt(5)
  v_mfma_f32_32x32x16_bf16 v[108:123], v[196:199], v[228:231], v[108:123]
  s_waitcnt lgkmcnt(4)
  v_mfma_f32_32x32x16_bf16 v[108:123], v[200:203], v[232:235], v[108:123]
  s_waitcnt lgkmcnt(3)
  v_mfma_f32_32x32x16_bf16 v[108:123], v[204:207], v[236:239], v[108:123]
  s_waitcnt lgkmcnt(2)
  v_mfma_f32_32x32x16_bf16 v[108:123], v[208:211], v[240:243], v[108:123]
  s_waitcnt lgkmcnt(1)
  v_mfma_f32_32x32x16_bf16 v[108:123], v[212:215], v[244:247], v[108:123]
  s_waitcnt lgkmcnt(0)
  v_mfma_f32_32x32x16_bf16 v[108:123], v[216:219], v[248:251], v[108:123]
  s_mov_b32 s22, 0xbfb8aa3b
  s_nop 10
  v_pk_mul_f32 v[124:125], v[108:109], s[22:23] op_sel_hi:[1,0]
  v_pk_mul_f32 v[126:127], v[110:111], s[22:23] op_sel_hi:[1,0]
  v_pk_mul_f32 v[128:129], v[112:113], s[22:23] op_sel_hi:[1,0]
  v_pk_mul_f32 v[130:131], v[114:115], s[22:23] op_sel_hi:[1,0]
  v_pk_mul_f32 v[132:133], v[116:117], s[22:23] op_sel_hi:[1,0]
  v_pk_mul_f32 v[134:135], v[118:119], s[22:23] op_sel_hi:[1,0]
  v_pk_mul_f32 v[136:137], v[120:121], s[22:23] op_sel_hi:[1,0]
  v_pk_mul_f32 v[138:139], v[122:123], s[22:23] op_sel_hi:[1,0]
  v_exp_f32 v124, v124
  v_exp_f32 v125, v125
  v_exp_f32 v126, v126
  v_exp_f32 v127, v127
  v_exp_f32 v128, v128
  v_exp_f32 v129, v129
  v_exp_f32 v130, v130
  v_exp_f32 v131, v131
  v_exp_f32 v132, v132
  v_exp_f32 v133, v133
  v_exp_f32 v134, v134
  v_exp_f32 v135, v135
  v_exp_f32 v136, v136
  v_exp_f32 v137, v137
  v_exp_f32 v138, v138
  v_exp_f32 v139, v139
  v_pk_add_f32 v[124:125], v[124:125], v[30:31]
  v_pk_add_f32 v[126:127], v[126:127], v[30:31]
  v_pk_add_f32 v[128:129], v[128:129], v[30:31]
  v_pk_add_f32 v[130:131], v[130:131], v[30:31]
  v_pk_add_f32 v[132:133], v[132:133], v[30:31]
  v_pk_add_f32 v[134:135], v[134:135], v[30:31]
  v_pk_add_f32 v[136:137], v[136:137], v[30:31]
  v_pk_add_f32 v[138:139], v[138:139], v[30:31]
  v_rcp_f32 v124, v124
  v_rcp_f32 v125, v125
  v_rcp_f32 v126, v126
  v_rcp_f32 v127, v127
  v_rcp_f32 v128, v128
  v_rcp_f32 v129, v129
  v_rcp_f32 v130, v130
  v_rcp_f32 v131, v131
  v_rcp_f32 v132, v132
  v_rcp_f32 v133, v133
  v_rcp_f32 v134, v134
  v_rcp_f32 v135, v135
  v_rcp_f32 v136, v136
  v_rcp_f32 v137, v137
  v_rcp_f32 v138, v138
  v_rcp_f32 v139, v139
  v_pk_mul_f32 v[108:109], v[108:109], v[124:125]
  v_pk_mul_f32 v[110:111], v[110:111], v[126:127]
  v_pk_mul_f32 v[112:113], v[112:113], v[128:129]
  v_pk_mul_f32 v[114:115], v[114:115], v[130:131]
  v_pk_mul_f32 v[116:117], v[116:117], v[132:133]
  v_pk_mul_f32 v[118:119], v[118:119], v[134:135]
  v_pk_mul_f32 v[120:121], v[120:121], v[136:137]
  v_pk_mul_f32 v[122:123], v[122:123], v[138:139]
  v_cvt_pk_bf16_f32 v92, v108, v109
  v_cvt_pk_bf16_f32 v93, v110, v111
  v_cvt_pk_bf16_f32 v94, v112, v113
  v_cvt_pk_bf16_f32 v95, v114, v115
  v_cvt_pk_bf16_f32 v96, v116, v117
  v_cvt_pk_bf16_f32 v97, v118, v119
  v_cvt_pk_bf16_f32 v98, v120, v121
  v_cvt_pk_bf16_f32 v99, v122, v123
  s_nop 1
  v_permlane32_swap_b32 v92, v94
  v_permlane32_swap_b32 v93, v95
  v_permlane32_swap_b32 v96, v98
  v_permlane32_swap_b32 v97, v99
  buffer_store_dwordx4 v[92:95], v34, s[40:43], 0 offen
  buffer_store_dwordx4 v[96:99], v34, s[40:43], 0 offen offset:32

  s_or_b32 s22, s2, s3
  s_cmp_eq_u32 s22, 0
  s_cbranch_scc1 K_ADV
K_ADVB:

K_END:
  s_endpgm
K_BOVF:
  v_mov_b32 v132, -2
  v_cmp_le_u32 vcc, s79, v108
  v_min_u32 v108, s79, v108
  s_nop 0
  v_cndmask_b32 v92, v92, v132, vcc
  v_cmp_le_u32 vcc, s79, v109
  v_min_u32 v109, s79, v109
  s_nop 0
  v_cndmask_b32 v93, v93, v132, vcc
  v_cmp_le_u32 vcc, s79, v110
  v_min_u32 v110, s79, v110
  s_nop 0
  v_cndmask_b32 v94, v94, v132, vcc
  v_cmp_le_u32 vcc, s79, v111
  v_min_u32 v111, s79, v111
  s_nop 0
  v_cndmask_b32 v95, v95, v132, vcc
  v_cmp_le_u32 vcc, s79, v112
  v_min_u32 v112, s79, v112
  s_nop 0
  v_cndmask_b32 v96, v96, v132, vcc
  s_branch K_BOVB
L_i7_1:
  s_mov_b32 m0, 0
  s_nop 0
  global_load_lds_dwordx4 v4, s[78:79]
  s_branch L_i7_1b
K2_B1:
  v_mov_b32 v7, s57
  s_mov_b64 exec, 1
  buffer_store_dword v7, off, s[40:43], s89 sc1
  s_mov_b64 exec, -1

  s_branch K2_B2
K2_B3:
  s_sleep 2
  s_branch K2_B2
K_POLL2:
  s_sleep 12
  s_branch K_POLL
K2_CR:
  s_mov_b64 s[74:75], s[76:77]
K2_CR1:
  s_waitcnt vmcnt(0)
  v_bitop3_b32 v80, v96, v97, v98 bitop3:0x96
  v_xor_b32 v80, v80, v99
  s_nop 1
  v_xor_b32_dpp v80, v80, v80 quad_perm:[1,0,3,2] row_mask:0xf bank_mask:0xf
  s_nop 1
  v_xor_b32_dpp v80, v80, v80 quad_perm:[2,3,0,1] row_mask:0xf bank_mask:0xf
  v_xor_b32 v80, s57, v80
  v_cmp_lt_u32 vcc, 1, v80
  s_and_b64 s[74:75], s[74:75], vcc
  s_cbranch_scc0 K2_CR2
  s_sleep 2
  s_mov_b64 exec, s[74:75]
  buffer_load_dwordx4 v[96:99], v3, s[24:27], s23 offen sc1
  s_mov_b64 exec, -1
  s_branch K2_CR1
K2_CR2:
  v_cmp_eq_u32 vcc, 1, v80
  v_mov_b32 v2, 1008
  s_and_b64 exec, vcc, s[76:77]
  ds_write_b32 v2, v72
  s_mov_b32 exec_lo, 0x88888888
  s_mov_b32 exec_hi, 0x88888888
  v_mov_b32 v99, -1
  s_mov_b64 exec, -1

  v_cmp_gt_u32 vcc, -2, v96
  s_cbranch_vccz K2_CRB
  v_lshrrev_b32 v128, 12, v96
  v_and_b32 v128, 0xfc, v128
  s_mov_b64 exec, vcc
  ds_add_rtn_u32 v104, v128, v72 offset:256
  s_mov_b64 exec, -1

  v_cmp_gt_u32 vcc, -2, v97
  s_cbranch_vccz K2_CRB
  v_lshrrev_b32 v129, 12, v97
  v_and_b32 v129, 0xfc, v129
  s_mov_b64 exec, vcc
  ds_add_rtn_u32 v105, v129, v72 offset:256
  s_mov_b64 exec, -1

  v_cmp_gt_u32 vcc, -2, v98
  s_cbranch_vccz K2_CRB
  v_lshrrev_b32 v130, 12, v98
  v_and_b32 v130, 0xfc, v130
  s_mov_b64 exec, vcc
  ds_add_rtn_u32 v106, v130, v72 offset:256
  s_mov_b64 exec, -1

  v_cmp_gt_u32 vcc, -2, v99
  s_cbranch_vccz K2_CRB
  v_lshrrev_b32 v131, 12, v99
  v_and_b32 v131, 0xfc, v131
  s_mov_b64 exec, vcc
  ds_add_rtn_u32 v107, v131, v72 offset:256
  s_mov_b64 exec, -1

  s_branch K2_CRB
K2_SR:
  s_mov_b64 exec, -1
  v_cmp_gt_u32 vcc, -2, v96
  s_cbranch_vccz K2_SRB
  ds_bpermute_b32 v136, v128, v7
  v_lshrrev_b32 v117, 20, v96
  v_add_u32 v117, v117, v21
  s_waitcnt lgkmcnt(0)

  s_mov_b64 exec, vcc
  v_add_u32_sdwa v104, v136, v104 dst_sel:DWORD dst_unused:UNUSED_PAD src0_sel:WORD_0 src1_sel:DWORD
  v_bfi_b32 v116, s84, v96, v136
  v_lshlrev_b32 v136, 3, v104
  v_lshrrev_b32 v104, 2, v104
  ds_write_b64 v136, v[116:117] offset:1024
  ds_write_b8 v104, v128 offset:512

  s_mov_b64 exec, -1
  v_cmp_gt_u32 vcc, -2, v97
  s_cbranch_vccz K2_SRB
  ds_bpermute_b32 v137, v129, v7
  v_lshrrev_b32 v117, 20, v97
  v_add_u32 v117, v117, v21
  s_waitcnt lgkmcnt(0)

  s_mov_b64 exec, vcc
  v_add_u32_sdwa v105, v137, v105 dst_sel:DWORD dst_unused:UNUSED_PAD src0_sel:WORD_0 src1_sel:DWORD
  v_bfi_b32 v116, s84, v97, v137
  v_lshlrev_b32 v137, 3, v105
  v_lshrrev_b32 v105, 2, v105
  ds_write_b64 v137, v[116:117] offset:1024
  ds_write_b8 v105, v129 offset:512

  s_mov_b64 exec, -1
  v_cmp_gt_u32 vcc, -2, v98
  s_cbranch_vccz K2_SRB
  ds_bpermute_b32 v138, v130, v7
  v_lshrrev_b32 v117, 20, v98
  v_add_u32 v117, v117, v21
  s_waitcnt lgkmcnt(0)

  s_mov_b64 exec, vcc
  v_add_u32_sdwa v106, v138, v106 dst_sel:DWORD dst_unused:UNUSED_PAD src0_sel:WORD_0 src1_sel:DWORD
  v_bfi_b32 v116, s84, v98, v138
  v_lshlrev_b32 v138, 3, v106
  v_lshrrev_b32 v106, 2, v106
  ds_write_b64 v138, v[116:117] offset:1024
  ds_write_b8 v106, v130 offset:512

  s_mov_b64 exec, -1
  v_cmp_gt_u32 vcc, -2, v99
  s_cbranch_vccz K2_SRB
  ds_bpermute_b32 v139, v131, v7
  v_lshrrev_b32 v117, 20, v99
  v_add_u32 v117, v117, v21
  s_waitcnt lgkmcnt(0)

  s_mov_b64 exec, vcc
  v_add_u32_sdwa v107, v139, v107 dst_sel:DWORD dst_unused:UNUSED_PAD src0_sel:WORD_0 src1_sel:DWORD
  v_bfi_b32 v116, s84, v99, v139
  v_lshlrev_b32 v139, 3, v107
  v_lshrrev_b32 v107, 2, v107
  ds_write_b64 v139, v[116:117] offset:1024
  ds_write_b8 v107, v131 offset:512

  s_branch K2_SRB
K2_RPOLL:
  buffer_load_dword v10, off, s[40:43], s87 sc1
  s_waitcnt vmcnt(0)
  v_cmp_ne_u32 vcc, s57, v10
  s_cbranch_vccz K2_RDY
  s_sleep 1
  s_branch K2_RPOLL
K2_SPOLL:
  s_mov_b32 s23, 0
K2_SP2:
  s_buffer_load_dword s22, s[40:43], s87 glc
  s_waitcnt lgkmcnt(0)
  s_cmp_eq_u32 s22, s57
  s_cbranch_scc1 K2_RDY
  s_add_u32 s23, s23, 1
  s_cmp_lt_u32 s23, 16
  s_cbranch_scc1 K2_SP2
  s_branch K2_RPOLL
L_sw_2:
  v_mov_b32 v40, v46
  v_mov_b32 v41, v47
  s_nop 0
  s_branch L_swb_3
L_uv_4:
  s_sub_u32 s23, s55, s82
  s_cmp_ge_u32 s23, 8
  s_cbranch_scc1 L_uv_4y
  s_cmp_ge_u32 s23, 4
  s_cbranch_scc1 L_uv_4x
  s_add_u32 s22, s88, 0
  buffer_load_dwordx4 v[156:159], v4, s[24:27], s22 offen offset:0
  s_add_u32 s22, s88, 0
  buffer_load_dwordx4 v[160:163], v4, s[24:27], s22 offen offset:1024
  s_branch L_vb_5
L_uv_4x:
  s_add_u32 s22, s88, 32768
  buffer_load_dwordx4 v[188:191], v4, s[24:27], s22 offen offset:0
  s_add_u32 s22, s88, 32768
  buffer_load_dwordx4 v[192:195], v4, s[24:27], s22 offen offset:1024
L_uv_4y:
  s_cmp_eq_u32 s55, s86
  s_cbranch_scc1 K2_LAST1
  s_branch L_vb_5
L_sw_6:
  v_mov_b32 v40, v46
  v_mov_b32 v41, v47
  s_nop 0
  s_branch L_swb_7
L_uv_9:
  s_sub_u32 s23, s55, s82
  s_cmp_ge_u32 s23, 8
  s_cbranch_scc1 L_uv_9y
  s_cmp_ge_u32 s23, 4
  s_cbranch_scc1 L_uv_9x
  s_add_u32 s22, s88, 0
  buffer_load_dwordx4 v[164:167], v4, s[24:27], s22 offen offset:2048
  s_add_u32 s22, s88, 0
  buffer_load_dwordx4 v[168:171], v4, s[24:27], s22 offen offset:3072
  s_branch L_vb_10
L_uv_9x:
  s_add_u32 s22, s88, 32768
  buffer_load_dwordx4 v[196:199], v4, s[24:27], s22 offen offset:2048
  s_add_u32 s22, s88, 32768
  buffer_load_dwordx4 v[200:203], v4, s[24:27], s22 offen offset:3072
L_uv_9y:
  s_cmp_eq_u32 s55, s86
  s_cbranch_scc1 K2_LAST0
  s_branch L_vb_10
L_sw_11:
  v_mov_b32 v40, v46
  v_mov_b32 v41, v47
  s_nop 0
  s_branch L_swb_12
L_fw_13:
  ds_read_b32 v7, v14
  s_waitcnt lgkmcnt(0)
  v_cmp_gt_u32 vcc, v8, v7
  s_cbranch_vccnz L_fw_13
  s_branch L_fb_14
L_uv_15:
  s_sub_u32 s23, s55, s82
  s_cmp_ge_u32 s23, 8
  s_cbranch_scc1 L_uv_15y
  s_cmp_ge_u32 s23, 4
  s_cbranch_scc1 L_uv_15x
  s_add_u32 s22, s88, 4096
  buffer_load_dwordx4 v[172:175], v4, s[24:27], s22 offen offset:0
  s_add_u32 s22, s88, 4096
  buffer_load_dwordx4 v[176:179], v4, s[24:27], s22 offen offset:1024
  s_branch L_vb_16
L_uv_15x:
  s_add_u32 s22, s88, 36864
  buffer_load_dwordx4 v[204:207], v4, s[24:27], s22 offen offset:0
  s_add_u32 s22, s88, 36864
  buffer_load_dwordx4 v[208:211], v4, s[24:27], s22 offen offset:1024
L_uv_15y:
  s_cmp_eq_u32 s55, s86
  s_cbranch_scc1 K2_LAST1
  s_branch L_vb_16
L_sw_17:
  v_mov_b32 v40, v46
  v_mov_b32 v41, v47
  s_nop 0
  s_branch L_swb_18
L_uv_19:
  s_sub_u32 s23, s55, s82
  s_cmp_ge_u32 s23, 8
  s_cbranch_scc1 L_uv_19y
  s_cmp_ge_u32 s23, 4
  s_cbranch_scc1 L_uv_19x
  s_add_u32 s22, s88, 4096
  buffer_load_dwordx4 v[180:183], v4, s[24:27], s22 offen offset:2048
  s_add_u32 s22, s88, 4096
  buffer_load_dwordx4 v[184:187], v4, s[24:27], s22 offen offset:3072
  s_branch L_vb_20
L_uv_19x:
  s_add_u32 s22, s88, 36864
  buffer_load_dwordx4 v[212:215], v4, s[24:27], s22 offen offset:2048
  s_add_u32 s22, s88, 36864
  buffer_load_dwordx4 v[216:219], v4, s[24:27], s22 offen offset:3072
L_uv_19y:
  s_cmp_eq_u32 s55, s86
  s_cbranch_scc1 K2_LAST0
  s_branch L_vb_20
K2_ULD:
  s_add_u32 s22, s88, 0
  buffer_load_dwordx4 v[156:159], v4, s[24:27], s22 offen offset:0
  s_add_u32 s22, s88, 0
  buffer_load_dwordx4 v[160:163], v4, s[24:27], s22 offen offset:1024
  s_add_u32 s22, s88, 0
  buffer_load_dwordx4 v[164:167], v4, s[24:27], s22 offen offset:2048
  s_add_u32 s22, s88, 0
  buffer_load_dwordx4 v[168:171], v4, s[24:27], s22 offen offset:3072
  s_add_u32 s22, s88, 4096
  buffer_load_dwordx4 v[172:175], v4, s[24:27], s22 offen offset:0
  s_add_u32 s22, s88, 4096
  buffer_load_dwordx4 v[176:179], v4, s[24:27], s22 offen offset:1024
  s_add_u32 s22, s88, 4096
  buffer_load_dwordx4 v[180:183], v4, s[24:27], s22 offen offset:2048
  s_add_u32 s22, s88, 4096
  buffer_load_dwordx4 v[184:187], v4, s[24:27], s22 offen offset:3072
  s_add_u32 s22, s88, 32768
  buffer_load_dwordx4 v[188:191], v4, s[24:27], s22 offen offset:0
  s_add_u32 s22, s88, 32768
  buffer_load_dwordx4 v[192:195], v4, s[24:27], s22 offen offset:1024
  s_add_u32 s22, s88, 32768
  buffer_load_dwordx4 v[196:199], v4, s[24:27], s22 offen offset:2048
  s_add_u32 s22, s88, 32768
  buffer_load_dwordx4 v[200:203], v4, s[24:27], s22 offen offset:3072
  s_add_u32 s22, s88, 36864
  buffer_load_dwordx4 v[204:207], v4, s[24:27], s22 offen offset:0
  s_add_u32 s22, s88, 36864
  buffer_load_dwordx4 v[208:211], v4, s[24:27], s22 offen offset:1024
  s_add_u32 s22, s88, 36864
  buffer_load_dwordx4 v[212:215], v4, s[24:27], s22 offen offset:2048
  s_add_u32 s22, s88, 36864
  buffer_load_dwordx4 v[216:219], v4, s[24:27], s22 offen offset:3072
  s_waitcnt vmcnt(0)
  v_mfma_f32_32x32x16_bf16 v[108:123], v[156:159], v[220:223], 0
  v_mfma_f32_32x32x16_bf16 v[108:123], v[160:163], v[224:227], v[108:123]
  v_mfma_f32_32x32x16_bf16 v[108:123], v[164:167], v[228:231], v[108:123]
  v_mfma_f32_32x32x16_bf16 v[108:123], v[168:171], v[232:235], v[108:123]
  v_mfma_f32_32x32x16_bf16 v[108:123], v[172:175], v[236:239], v[108:123]
  v_mfma_f32_32x32x16_bf16 v[108:123], v[176:179], v[240:243], v[108:123]
  v_mfma_f32_32x32x16_bf16 v[108:123], v[180:183], v[244:247], v[108:123]
  v_mfma_f32_32x32x16_bf16 v[108:123], v[184:187], v[248:251], v[108:123]
  s_branch K2_ULB
K2_TRIP:
  s_or_b32 s22, s60, s83
  s_cmp_lg_u32 s22, 0
  s_cbranch_scc1 K2_TRB
  s_branch K2_REDO
K2_GS2:
  ds_read_b32 v7, v14
  s_branch K2_GS
K_ADV:
  v_mov_b32 v1, s57
  s_mov_b32 s22, 2621184
  s_mov_b64 exec, 1
  buffer_store_dword v1, off, s[24:27], s22 sc1
  s_mov_b64 exec, -1
  s_branch K_ADVB
K_SPECIAL:
  s_waitcnt lgkmcnt(0)
  s_mov_b32 s22, 2621184
  s_load_dword s57, s[20:21], s22

  s_mov_b32 s24, s20
  s_mov_b32 s25, s21
  s_mov_b32 s26, 7438336
  s_mov_b32 s27, 0x00020000
  s_cmp_lg_u32 s2, 0
  s_cbranch_scc1 K_HELPER
  s_cmp_lg_u32 s3, 0
  s_cbranch_scc1 K_END
  s_waitcnt lgkmcnt(0)
  s_add_u32 s57, s57, 2
  s_or_b32 s57, s57, 0x40000001
  v_mov_b32 v1, s57

  s_mov_b32 s40, s16
  s_mov_b32 s41, s17
  s_mov_b32 s42, 2560000
  s_mov_b32 s43, 0x00020000
  v_mul_u32_u24 v2, 20480, v0
  v_and_b32 v6, 7, v0
  v_lshl_add_u32 v2, v6, 7, v2
  v_add_u32 v2, 18432, v2
  v_add_u32 v4, 1310720, v2
  v_cmp_gt_u32 vcc, 61, v0
  v_mul_u32_u24 v5, 20480, v0
  v_add_u32 v5, -1241088, v5
  v_cndmask_b32 v4, v5, v4, vcc
  v_cmp_le_u32 vcc, 63, v0
  v_mul_u32_u24 v3, 10240, v0
  v_bfe_u32 v6, v0, 1, 3
  v_lshl_add_u32 v3, v6, 7, v3
  v_add_u32 v3, 9216, v3
  v_cndmask_b32 v4, v4, v2, vcc
  s_mov_b32 s76, 655360
  s_mov_b32 s77, 1310720
  s_mov_b32 s78, 1966080

K_MPOLL:
  buffer_load_dword v8, v2, s[40:43], 0 offen sc1
  buffer_load_dword v9, v4, s[40:43], 0 offen sc1
  s_waitcnt vmcnt(0)
  v_xor_b32 v8, v1, v8
  v_xor_b32 v9, v1, v9
  v_or_b32 v8, v8, v9
  v_cmp_ne_u32 vcc, 0, v8
  s_cbranch_vccnz K_MPOLL
  buffer_store_dword v1, v3, s[40:43], 0 offen sc1
  buffer_store_dword v1, v3, s[40:43], s76 offen sc1
  buffer_store_dword v1, v3, s[40:43], s77 offen sc1
  buffer_store_dword v1, v3, s[40:43], s78 offen sc1

  s_endpgm
K_HELPER:
  s_sub_u32 s87, s2, 1
  s_lshl_b32 s82, s87, 15
  s_lshl_b32 s77, s3, 12

  s_add_u32 s64, s14, s82
  s_addc_u32 s65, s15, 0
  s_mov_b32 s66, 32768
  s_mov_b32 s67, 0x00020000
  s_add_u32 m0, s77, 0
  s_nop 0
  buffer_load_dwordx4 v56, s[64:67], s77 offen offset:0 lds
  buffer_load_dwordx4 v56, s[64:67], s77 offen offset:1024 lds
  buffer_load_dwordx4 v56, s[64:67], s77 offen offset:2048 lds
  buffer_load_dwordx4 v56, s[64:67], s77 offen offset:3072 lds
  s_waitcnt vmcnt(4)
  s_lshl_b32 s22, s53, 6
  v_xor_b32 v53, s22, v53
  v_lshrrev_b32 v58, 5, v5
  s_sub_u32 s22, 11, s87
  v_lshlrev_b32 v58, s22, v58
  v_add_u32 v53, v53, v58
  s_lshl_b32 s22, s52, 14
  v_add_u32 v53, s22, v53
  s_lshl_b32 s22, 1024, s87
  v_add_u32 v58, s22, v53
  s_lshl_b32 s22, s53, 13
  s_add_u32 s82, s82, s22
  s_lshl_b32 s22, s52, 12
  s_add_u32 s82, s82, s22
  s_add_u32 s82, s82, 7372800
  s_waitcnt vmcnt(0)
  s_barrier

  ds_read_b64_tr_b16 v[92:93], v53 offset:0
  ds_read_b64_tr_b16 v[94:95], v58 offset:0
  ds_read_b64_tr_b16 v[96:97], v53 offset:4096
  ds_read_b64_tr_b16 v[98:99], v58 offset:4096
  ds_read_b64_tr_b16 v[100:101], v53 offset:8192
  ds_read_b64_tr_b16 v[102:103], v58 offset:8192
  ds_read_b64_tr_b16 v[104:105], v53 offset:12288
  ds_read_b64_tr_b16 v[106:107], v58 offset:12288
  s_waitcnt lgkmcnt(0)
  buffer_store_dwordx4 v[92:95], v4, s[24:27], s82 offen offset:0 sc1
  buffer_store_dwordx4 v[96:99], v4, s[24:27], s82 offen offset:1024 sc1
  buffer_store_dwordx4 v[100:103], v4, s[24:27], s82 offen offset:2048 sc1
  buffer_store_dwordx4 v[104:107], v4, s[24:27], s82 offen offset:3072 sc1
  s_waitcnt vmcnt(0)
  s_barrier
  s_cmp_lg_u32 s3, 0
  s_cbranch_scc1 K_END
  s_add_u32 s57, s57, 2
  s_or_b32 s57, s57, 0x40000001
  v_mov_b32 v1, s57

  s_mov_b32 s40, s16
  s_mov_b32 s41, s17
  s_mov_b32 s42, 2560000
  s_mov_b32 s43, 0x00020000
  s_mul_i32 s22, s87, 20480
  s_add_u32 s22, s22, 8192
  s_mov_b64 exec, 1
  buffer_store_dword v1, off, s[40:43], s22 sc1
  s_endpgm

K2_SAFEP:
  s_waitcnt lgkmcnt(0)
  v_mfma_f32_32x32x16_bf16 v[92:107], v[56:59], v[36:39], 0
  ds_read_b128 v[56:59], v16 offset:4096
  v_mfma_f32_32x32x16_bf16 v[92:107], v[60:63], v[40:43], v[92:107]
  ds_read_b128 v[60:63], v12
  ds_read_u8 v12, v18 offset:512
  v_mfma_f32_32x32x16_bf16 v[92:107], v[64:67], v[48:51], v[92:107]
  s_cmp_lg_u32 s83, 0
  s_cselect_b32 s59, s63, s59
  s_cmp_lt_u32 s59, s63
  s_cselect_b32 s23, s59, 161024
  s_add_u32 s59, s59, 6144
  v_mfma_f32_32x32x16_bf16 v[92:107], v[68:71], v[52:55], v[92:107]
  s_setprio 0
  s_add_u32 m0, s58, 4096
  s_nop 0
  buffer_load_dwordx4 v[24:25], s[28:31], 0 idxen offen lds
  s_add_u32 m0, s58, 5120
  ds_read_u16 v24, v17 offset:1024
  buffer_load_dwordx4 v[26:27], s[28:31], 0 idxen offen lds

  v_mov_b32 v28, v122
  s_add_u32 m0, s58, 6144
  ds_read_u16 v26, v17 offset:1088
  buffer_load_dwordx4 v[118:119], s[28:31], 0 idxen offen lds
  s_add_u32 m0, s58, 7168
  s_nop 0
  buffer_load_dwordx4 v[120:121], s[28:31], 0 idxen offen lds

  s_mov_b32 m0, s23
  s_waitcnt vmcnt(4) lgkmcnt(0)
  buffer_load_dwordx4 v[28:29], s[32:35], 0 idxen offen lds
  s_add_u32 m0, s58, 0
  ds_read_b128 v[64:67], v20 offset:2048
  buffer_load_dwordx4 v[24:25], s[28:31], 0 idxen offen lds
  s_add_u32 m0, s58, 1024
  ds_read_b128 v[68:71], v13 offset:2048
  buffer_load_dwordx4 v[26:27], s[28:31], 0 idxen offen lds
  ds_read_u16 v24, v17 offset:1280
  ds_read_u16 v26, v17 offset:1344
  s_nop 0
K2_SAFE:
  v_exp_f32 v124, v92
  v_exp_f32 v125, v93
  v_exp_f32 v132, v100
  v_exp_f32 v133, v101
  v_exp_f32 v126, v94
  v_exp_f32 v127, v95
  v_exp_f32 v134, v102
  v_exp_f32 v135, v103
  v_exp_f32 v128, v96
  v_exp_f32 v129, v97
  v_exp_f32 v136, v104
  v_exp_f32 v137, v105
  v_exp_f32 v130, v98
  v_exp_f32 v131, v99
  v_exp_f32 v138, v106
  v_exp_f32 v139, v107
  v_add_u32 v8, 1, v8
  s_setprio 1
  v_cvt_pk_bf16_f32 v78, v80, v81
  v_cvt_pk_bf16_f32 v79, v82, v83
  v_pk_add_f32 v[124:125], v[124:125], v[30:31]
  v_pk_add_f32 v[126:127], v[126:127], v[30:31]
  v_pk_add_f32 v[128:129], v[128:129], v[30:31]
  v_pk_add_f32 v[130:131], v[130:131], v[30:31]
  v_pk_add_f32 v[132:133], v[132:133], v[30:31]
  v_pk_add_f32 v[134:135], v[134:135], v[30:31]
  v_pk_add_f32 v[136:137], v[136:137], v[30:31]
  v_pk_add_f32 v[138:139], v[138:139], v[30:31]
  v_rcp_f32 v124, v124
  v_rcp_f32 v125, v125
  v_rcp_f32 v126, v126
  v_rcp_f32 v127, v127
  v_rcp_f32 v128, v128
  v_rcp_f32 v129, v129
  v_rcp_f32 v130, v130
  v_rcp_f32 v131, v131
  v_rcp_f32 v132, v132
  v_rcp_f32 v133, v133
  v_rcp_f32 v134, v134
  v_rcp_f32 v135, v135
  v_rcp_f32 v136, v136
  v_rcp_f32 v137, v137
  v_rcp_f32 v138, v138
  v_rcp_f32 v139, v139
  s_nop 0
  v_pk_mul_f32 v[92:93], v[92:93], v[124:125]
  v_pk_mul_f32 v[100:101], v[100:101], v[132:133]
  v_pk_fma_f32 v[92:93], v[94:95], v[126:127], v[92:93]
  v_pk_fma_f32 v[100:101], v[102:103], v[134:135], v[100:101]
  v_pk_fma_f32 v[92:93], v[96:97], v[128:129], v[92:93]
  v_pk_fma_f32 v[100:101], v[104:105], v[136:137], v[100:101]
  v_pk_fma_f32 v[80:81], v[98:99], v[130:131], v[92:93]
  v_pk_fma_f32 v[82:83], v[106:107], v[138:139], v[100:101]
  s_setprio 2
  s_add_u32 s55, s55, 1
  s_cmp_ge_u32 s55, s54
  s_cbranch_scc1 K2_SEXIT
  s_waitcnt lgkmcnt(0)
  v_mfma_f32_32x32x16_bf16 v[140:155], v[76:79], v[72:75], v[140:155]
  s_cmp_eq_u32 s55, s56
  s_cbranch_scc1 L_sw_21
L_swb_22:
  v_mfma_f32_32x32x16_bf16 v[92:107], v[56:59], v[36:39], 0
  ds_read_b128 v[56:59], v16 offset:6144
  v_mfma_f32_32x32x16_bf16 v[92:107], v[60:63], v[40:43], v[92:107]
  ds_read_b128 v[60:63], v12
  ds_read_u8 v12, v18 offset:768
  v_mfma_f32_32x32x16_bf16 v[92:107], v[64:67], v[48:51], v[92:107]
  s_add_u32 m0, s58, 2048
  v_mfma_f32_32x32x16_bf16 v[92:107], v[68:71], v[52:55], v[92:107]
  s_setprio 0
  s_waitcnt vmcnt(5)
  ds_read_b128 v[64:67], v20 offset:4096
  buffer_load_dwordx4 v[24:25], s[28:31], 0 idxen offen lds
  s_add_u32 m0, s58, 3072
  ds_read_b128 v[68:71], v13 offset:4096
  buffer_load_dwordx4 v[26:27], s[28:31], 0 idxen offen lds
  ds_read_u16 v24, v17 offset:1536
  ds_read_u16 v26, v17 offset:1600
  s_nop 2
  v_exp_f32 v124, v92
  v_exp_f32 v125, v93
  v_exp_f32 v132, v100
  v_exp_f32 v133, v101
  v_exp_f32 v126, v94
  v_exp_f32 v127, v95
  v_exp_f32 v134, v102
  v_exp_f32 v135, v103
  v_exp_f32 v128, v96
  v_exp_f32 v129, v97
  v_exp_f32 v136, v104
  v_exp_f32 v137, v105
  v_exp_f32 v130, v98
  v_exp_f32 v131, v99
  v_exp_f32 v138, v106
  v_exp_f32 v139, v107
  s_setprio 1
  v_cvt_pk_bf16_f32 v76, v80, v81
  v_cvt_pk_bf16_f32 v77, v82, v83
  v_pk_add_f32 v[124:125], v[124:125], v[30:31]
  v_pk_add_f32 v[126:127], v[126:127], v[30:31]
  v_pk_add_f32 v[128:129], v[128:129], v[30:31]
  v_pk_add_f32 v[130:131], v[130:131], v[30:31]
  v_pk_add_f32 v[132:133], v[132:133], v[30:31]
  v_pk_add_f32 v[134:135], v[134:135], v[30:31]
  v_pk_add_f32 v[136:137], v[136:137], v[30:31]
  v_pk_add_f32 v[138:139], v[138:139], v[30:31]
  v_rcp_f32 v124, v124
  v_rcp_f32 v125, v125
  v_rcp_f32 v126, v126
  v_rcp_f32 v127, v127
  v_rcp_f32 v128, v128
  v_rcp_f32 v129, v129
  v_rcp_f32 v130, v130
  v_rcp_f32 v131, v131
  v_rcp_f32 v132, v132
  v_rcp_f32 v133, v133
  v_rcp_f32 v134, v134
  v_rcp_f32 v135, v135
  v_rcp_f32 v136, v136
  v_rcp_f32 v137, v137
  v_rcp_f32 v138, v138
  v_rcp_f32 v139, v139
  s_nop 0
  v_pk_mul_f32 v[92:93], v[92:93], v[124:125]
  v_pk_mul_f32 v[100:101], v[100:101], v[132:133]
  v_pk_fma_f32 v[92:93], v[94:95], v[126:127], v[92:93]
  v_pk_fma_f32 v[100:101], v[102:103], v[134:135], v[100:101]
  v_pk_fma_f32 v[92:93], v[96:97], v[128:129], v[92:93]
  v_pk_fma_f32 v[100:101], v[104:105], v[136:137], v[100:101]
  v_pk_fma_f32 v[80:81], v[98:99], v[130:131], v[92:93]
  v_pk_fma_f32 v[82:83], v[106:107], v[138:139], v[100:101]
  s_setprio 2
  s_add_u32 s55, s55, 1
  s_cmp_ge_u32 s55, s54
  s_cbranch_scc1 K2_SEXIT
  s_waitcnt lgkmcnt(0)
  v_mfma_f32_32x32x16_bf16 v[92:107], v[56:59], v[36:39], 0
  s_cmp_eq_u32 s55, s56
  s_cbranch_scc1 L_sw_23
L_swb_24:
  ds_read_b128 v[56:59], v16 offset:7168
  v_mfma_f32_32x32x16_bf16 v[92:107], v[60:63], v[40:43], v[92:107]
  ds_read_b128 v[60:63], v12
  ds_read_u8 v12, v18 offset:1024
  ds_read_b128 v[72:75], v16 offset:5120
  v_mfma_f32_32x32x16_bf16 v[92:107], v[64:67], v[48:51], v[92:107]
  s_add_u32 m0, s58, 4096
  v_mfma_f32_32x32x16_bf16 v[92:107], v[68:71], v[52:55], v[92:107]
  s_setprio 0
  s_waitcnt vmcnt(2)
  ds_read_b128 v[64:67], v20 offset:6144
  buffer_load_dwordx4 v[24:25], s[28:31], 0 idxen offen lds
  s_add_u32 m0, s58, 5120
  ds_read_b128 v[68:71], v13 offset:6144
  buffer_load_dwordx4 v[26:27], s[28:31], 0 idxen offen lds
  ds_read_u16 v24, v17 offset:1792
  ds_read_u16 v26, v17 offset:1856
  s_cmp_lg_u32 s83, 0
  s_cbranch_scc1 L_nf_25
  s_mov_b64 exec, 1
  ds_write_b32 v6, v8
  s_mov_b64 exec, -1
L_nf_25:
  s_nop 2
  v_exp_f32 v124, v92
  v_exp_f32 v125, v93
  v_exp_f32 v132, v100
  v_exp_f32 v133, v101
  v_exp_f32 v126, v94
  v_exp_f32 v127, v95
  v_exp_f32 v134, v102
  v_exp_f32 v135, v103
  v_exp_f32 v128, v96
  v_exp_f32 v129, v97
  v_exp_f32 v136, v104
  v_exp_f32 v137, v105
  v_exp_f32 v130, v98
  v_exp_f32 v131, v99
  v_exp_f32 v138, v106
  v_exp_f32 v139, v107
  s_setprio 1
  v_cvt_pk_bf16_f32 v78, v80, v81
  v_cvt_pk_bf16_f32 v79, v82, v83
  v_pk_add_f32 v[124:125], v[124:125], v[30:31]
  v_pk_add_f32 v[126:127], v[126:127], v[30:31]
  v_pk_add_f32 v[128:129], v[128:129], v[30:31]
  v_pk_add_f32 v[130:131], v[130:131], v[30:31]
  v_pk_add_f32 v[132:133], v[132:133], v[30:31]
  v_pk_add_f32 v[134:135], v[134:135], v[30:31]
  v_pk_add_f32 v[136:137], v[136:137], v[30:31]
  v_pk_add_f32 v[138:139], v[138:139], v[30:31]
  v_rcp_f32 v124, v124
  v_rcp_f32 v125, v125
  v_rcp_f32 v126, v126
  v_rcp_f32 v127, v127
  v_rcp_f32 v128, v128
  v_rcp_f32 v129, v129
  v_rcp_f32 v130, v130
  v_rcp_f32 v131, v131
  v_rcp_f32 v132, v132
  v_rcp_f32 v133, v133
  v_rcp_f32 v134, v134
  v_rcp_f32 v135, v135
  v_rcp_f32 v136, v136
  v_rcp_f32 v137, v137
  v_rcp_f32 v138, v138
  v_rcp_f32 v139, v139
  s_nop 0
  v_pk_mul_f32 v[92:93], v[92:93], v[124:125]
  v_pk_mul_f32 v[100:101], v[100:101], v[132:133]
  v_pk_fma_f32 v[92:93], v[94:95], v[126:127], v[92:93]
  v_pk_fma_f32 v[100:101], v[102:103], v[134:135], v[100:101]
  v_pk_fma_f32 v[92:93], v[96:97], v[128:129], v[92:93]
  v_pk_fma_f32 v[100:101], v[104:105], v[136:137], v[100:101]
  v_pk_fma_f32 v[80:81], v[98:99], v[130:131], v[92:93]
  v_pk_fma_f32 v[82:83], v[106:107], v[138:139], v[100:101]
  s_setprio 2
  s_add_u32 s55, s55, 1
  s_cmp_ge_u32 s55, s54
  s_cbranch_scc1 K2_SEXIT
  s_waitcnt lgkmcnt(0)
  v_mfma_f32_32x32x16_bf16 v[140:155], v[76:79], v[72:75], v[140:155]
  ds_read_b32 v7, v14
  s_cmp_eq_u32 s55, s56
  s_cbranch_scc1 L_sw_26
L_swb_27:
  v_mfma_f32_32x32x16_bf16 v[92:107], v[56:59], v[36:39], 0
  ds_read_b32 v28, v19 offset:2048
  v_mfma_f32_32x32x16_bf16 v[92:107], v[60:63], v[40:43], v[92:107]
  ds_read_b128 v[60:63], v12
  ds_read_u8 v12, v18 offset:1280
  v_mfma_f32_32x32x16_bf16 v[92:107], v[64:67], v[48:51], v[92:107]
  s_waitcnt lgkmcnt(3)
  v_cmp_gt_u32 vcc, v8, v7
  s_add_u32 m0, s58, 6144
  v_mfma_f32_32x32x16_bf16 v[92:107], v[68:71], v[52:55], v[92:107]
  s_setprio 0
  s_cmp_lg_u32 s83, 0
  s_cbranch_scc1 L_fb_29
  s_cbranch_vccnz L_fw_28
L_fb_29:
  ds_read_b128 v[56:59], v16 offset:9216
  s_waitcnt vmcnt(4)
  ds_read_b128 v[64:67], v20 offset:0
  buffer_load_dwordx4 v[24:25], s[28:31], 0 idxen offen lds
  s_add_u32 m0, s58, 7168
  ds_read_b128 v[68:71], v13 offset:0
  buffer_load_dwordx4 v[26:27], s[28:31], 0 idxen offen lds
  ds_read_u16 v24, v17 offset:2048
  ds_read_u16 v26, v17 offset:2112
  s_nop 0
  v_exp_f32 v124, v92
  v_exp_f32 v125, v93
  v_exp_f32 v132, v100
  v_exp_f32 v133, v101
  v_exp_f32 v126, v94
  v_exp_f32 v127, v95
  v_exp_f32 v134, v102
  v_exp_f32 v135, v103
  v_exp_f32 v128, v96
  v_exp_f32 v129, v97
  v_exp_f32 v136, v104
  v_exp_f32 v137, v105
  v_exp_f32 v130, v98
  v_exp_f32 v131, v99
  v_exp_f32 v138, v106
  v_exp_f32 v139, v107
  v_add_u32 v16, 6144, v16
  v_add_u32 v17, 1024, v17
  v_add_u32 v18, 1024, v18
  v_add_u32 v19, 1024, v19
  s_setprio 1
  v_cvt_pk_bf16_f32 v76, v80, v81
  v_cvt_pk_bf16_f32 v77, v82, v83
  v_pk_add_f32 v[124:125], v[124:125], v[30:31]
  v_pk_add_f32 v[126:127], v[126:127], v[30:31]
  v_pk_add_f32 v[128:129], v[128:129], v[30:31]
  v_pk_add_f32 v[130:131], v[130:131], v[30:31]
  v_pk_add_f32 v[132:133], v[132:133], v[30:31]
  v_pk_add_f32 v[134:135], v[134:135], v[30:31]
  v_pk_add_f32 v[136:137], v[136:137], v[30:31]
  v_pk_add_f32 v[138:139], v[138:139], v[30:31]
  v_rcp_f32 v124, v124
  v_rcp_f32 v125, v125
  v_rcp_f32 v126, v126
  v_rcp_f32 v127, v127
  v_rcp_f32 v128, v128
  v_rcp_f32 v129, v129
  v_rcp_f32 v130, v130
  v_rcp_f32 v131, v131
  v_rcp_f32 v132, v132
  v_rcp_f32 v133, v133
  v_rcp_f32 v134, v134
  v_rcp_f32 v135, v135
  v_rcp_f32 v136, v136
  v_rcp_f32 v137, v137
  v_rcp_f32 v138, v138
  v_rcp_f32 v139, v139
  s_nop 0
  v_pk_mul_f32 v[92:93], v[92:93], v[124:125]
  v_pk_mul_f32 v[100:101], v[100:101], v[132:133]
  v_pk_fma_f32 v[92:93], v[94:95], v[126:127], v[92:93]
  v_pk_fma_f32 v[100:101], v[102:103], v[134:135], v[100:101]
  v_pk_fma_f32 v[92:93], v[96:97], v[128:129], v[92:93]
  v_pk_fma_f32 v[100:101], v[104:105], v[136:137], v[100:101]
  v_pk_fma_f32 v[80:81], v[98:99], v[130:131], v[92:93]
  v_pk_fma_f32 v[82:83], v[106:107], v[138:139], v[100:101]
  s_setprio 2
  s_add_u32 s55, s55, 1
  s_cmp_ge_u32 s55, s54
  s_cbranch_scc1 K2_SEXIT
  s_waitcnt lgkmcnt(0)
  v_mfma_f32_32x32x16_bf16 v[92:107], v[56:59], v[36:39], 0
  s_cmp_eq_u32 s55, s56
  s_cbranch_scc1 L_sw_30
L_swb_31:
  ds_read_b128 v[56:59], v16 offset:4096
  v_mfma_f32_32x32x16_bf16 v[92:107], v[60:63], v[40:43], v[92:107]
  ds_read_b128 v[60:63], v12
  ds_read_u8 v12, v18 offset:512
  ds_read_b128 v[72:75], v16 offset:2048
  v_mfma_f32_32x32x16_bf16 v[92:107], v[64:67], v[48:51], v[92:107]
  s_cmp_lg_u32 s83, 0
  s_cselect_b32 s59, s63, s59
  s_cmp_lt_u32 s59, s63
  s_cselect_b32 m0, s59, 161024
  s_add_u32 s59, s59, 6144
  v_mfma_f32_32x32x16_bf16 v[92:107], v[68:71], v[52:55], v[92:107]
  s_setprio 0
  s_waitcnt vmcnt(4)
  buffer_load_dwordx4 v[28:29], s[32:35], 0 idxen offen lds
  s_add_u32 m0, s58, 0
  ds_read_b128 v[64:67], v20 offset:2048
  buffer_load_dwordx4 v[24:25], s[28:31], 0 idxen offen lds
  s_add_u32 m0, s58, 1024
  ds_read_b128 v[68:71], v13 offset:2048
  buffer_load_dwordx4 v[26:27], s[28:31], 0 idxen offen lds
  ds_read_u16 v24, v17 offset:1280
  ds_read_u16 v26, v17 offset:1344
  s_nop 0
  s_branch K2_SAFE
K2_SEXIT:
  s_setprio 0
  ds_read_b128 v[60:63], v15
  s_branch K2_X2

K2_REDO:
  s_lshr_b32 s23, s86, 2
  s_mul_i32 s22, s23, 6144
  s_lshl_b32 s23, s23, 10
  v_subrev_u32 v16, s22, v16
  v_subrev_u32 v17, s23, v17
  v_subrev_u32 v18, s23, v18
  v_subrev_u32 v19, s23, v19

  s_mov_b32 s82, 2147483647
  s_mov_b32 s83, 1
  v_mov_b64 v[140:141], 0
  v_mov_b64 v[142:143], 0
  v_mov_b64 v[144:145], 0
  v_mov_b64 v[146:147], 0
  v_mov_b64 v[148:149], 0
  v_mov_b64 v[150:151], 0
  v_mov_b64 v[152:153], 0
  v_mov_b64 v[154:155], 0
  v_mov_b32 v119, v25
  v_mov_b32 v121, v25
  s_mov_b32 m0, s58
  s_waitcnt vmcnt(0) lgkmcnt(0)
  s_branch K2_START
K2_OVF:
  s_cmp_eq_u32 s60, 0
  s_cbranch_scc0 K2_OV2
  s_cmp_lg_u32 s3, 0
  s_cbranch_scc1 K2_OV2
K2_OV1:
  buffer_load_dword v10, off, s[40:43], s87 sc1
  s_waitcnt vmcnt(0)
  v_cmp_ne_u32 vcc, s57, v10
  s_cbranch_vccnz K2_OV1
K2_OV2:
  s_mov_b32 s60, 1
  s_mov_b32 s61, 0
  s_branch K2_ROUND
K2_NEXTR:
  s_add_u32 s61, s61, 1
  s_cmp_ge_u32 s61, 625
  s_cbranch_scc1 K2_FIN

  s_lshr_b32 s23, s54, 2
  s_mul_i32 s22, s23, 6144
  s_lshl_b32 s23, s23, 10
  v_subrev_u32 v16, s22, v16
  v_subrev_u32 v17, s23, v17
  v_subrev_u32 v18, s23, v18
  v_subrev_u32 v19, s23, v19

K2_ROUND:
  s_load_dwordx4 s[76:79], s[0:1], 16
  s_waitcnt vmcnt(0) lgkmcnt(0)
  s_barrier

  s_mov_b32 s48, s76
  s_mov_b32 s49, s77
  s_mov_b32 s50, 1280000
  s_mov_b32 s51, 0x00020000
  s_mov_b32 s44, s78
  s_mov_b32 s45, s79
  s_mov_b32 s46, 1280000
  s_mov_b32 s47, 0x00020000
  v_mov_b32 v119, v25
  v_mov_b32 v121, v25
  v_mov_b32 v123, v29
  v_mov_b32 v72, 1
  v_mov_b64 v[92:93], -1
  v_mov_b64 v[94:95], -1
  v_mov_b64 v[96:97], -1
  v_mov_b64 v[98:99], -1

  s_lshl_b32 s22, s61, 9
  v_add_u32 v21, s22, v0
  v_lshlrev_b32 v1, 2, v21
  buffer_load_dword v92, v1, s[44:47], 0 offen
  buffer_load_dword v93, v1, s[48:51], 0 offen

  s_mul_i32 s22, s3, 3072
  s_add_u32 m0, s22, 17664
  s_brev_b32 s23, 2
  buffer_load_dwordx4 v4, s[24:27], s23 offen lds
  s_add_u32 m0, s22, 42240
  s_cmp_lt_u32 s3, 2
  buffer_load_dwordx4 v4, s[24:27], s23 offen lds
  s_cselect_b32 s79, s22, 69632
  s_add_u32 m0, s22, 66816
  s_lshl_b32 s22, s3, 10
  buffer_load_dwordx4 v4, s[24:27], s23 offen lds

  s_add_u32 m0, s79, 91392
  s_add_u32 s78, s80, 4096
  buffer_load_dwordx4 v4, s[24:27], s23 offen lds
  s_addc_u32 s79, s81, 0
  s_add_u32 m0, s22, 0
  s_cmp_eq_u32 s3, 7
  global_load_lds_dwordx4 v4, s[78:79] offset:1024
  s_cbranch_scc1 L_i7_32

  s_add_u32 m0, s22, 8192
  s_nop 0
  global_load_lds_dwordx4 v4, s[78:79] offset:1024
L_i7_32b:

  s_mul_i32 s22, s2, 40
  s_waitcnt vmcnt(0)
  v_subrev_u32 v92, s22, v92
  v_cmp_gt_u32 vcc, 40, v92
  v_lshl_or_b32 v1, v92, 14, v93
  v_mov_b32 v93, -1
  v_cndmask_b32 v92, -1, v1, vcc
  s_mov_b64 s[76:77], 0
  s_barrier
  s_branch K2_COUNT

L_sw_21:
  v_mov_b32 v40, v46
  v_mov_b32 v41, v47
  s_nop 0
  s_branch L_swb_22
L_sw_23:
  v_mov_b32 v40, v46
  v_mov_b32 v41, v47
  s_nop 0
  s_branch L_swb_24
L_sw_26:
  v_mov_b32 v40, v46
  v_mov_b32 v41, v47
  s_nop 0
  s_branch L_swb_27
L_fw_28:
  ds_read_b32 v7, v14
  s_waitcnt lgkmcnt(0)
  v_cmp_gt_u32 vcc, v8, v7
  s_cbranch_vccnz L_fw_28
  s_branch L_fb_29
L_sw_30:
  v_mov_b32 v40, v46
  v_mov_b32 v41, v47
  s_nop 0
  s_branch L_swb_31
L_i7_32:
  s_mov_b32 m0, 0
  s_nop 0
  global_load_lds_dwordx4 v4, s[78:79]
  s_branch L_i7_32b
K_CODE_END:
.section .rodata,"a"
.p2align 8
K_TABLE:
.long 0x3100, 0x400, 0x402, 0x404
.long 0x3120, 0x400, 0x422, 0x404
.long 0x3140, 0x400, 0x40a, 0x424
.long 0x3160, 0x400, 0x42a, 0x424
.long 0x3180, 0x420, 0x482, 0x40c
.long 0x31a0, 0x420, 0x4a2, 0x40c
.long 0x31c0, 0x420, 0x48a, 0x42c
.long 0x31e0, 0x420, 0x4aa, 0x42c
.long 0x3210, 0x408, 0x412, 0x484
.long 0x3230, 0x408, 0x432, 0x484
.long 0x3250, 0x408, 0x41a, 0x4a4
.long 0x3270, 0x408, 0x43a, 0x4a4
.long 0x3290, 0x428, 0x492, 0x48c
.long 0x32b0, 0x428, 0x4b2, 0x48c
.long 0x32d0, 0x428, 0x49a, 0x4ac
.long 0x32f0, 0x428, 0x4ba, 0x4ac
.long 0x3300, 0x480, 0x442, 0x414
.long 0x3320, 0x480, 0x462, 0x414
.long 0x3340, 0x480, 0x44a, 0x434
.long 0x3360, 0x480, 0x46a, 0x434
.long 0x3380, 0x4a0, 0x4c2, 0x41c
.long 0x33a0, 0x4a0, 0x4e2, 0x41c
.long 0x33c0, 0x4a0, 0x4ca, 0x43c
.long 0x33e0, 0x4a0, 0x4ea, 0x43c
.long 0x3410, 0x488, 0x452, 0x494
.long 0x3430, 0x488, 0x472, 0x494
.long 0x3450, 0x488, 0x45a, 0x4b4
.long 0x3470, 0x488, 0x47a, 0x4b4
.long 0x3490, 0x4a8, 0x4d2, 0x49c
.long 0x34b0, 0x4a8, 0x4f2, 0x49c
.long 0x34d0, 0x4a8, 0x4da, 0x4bc
.long 0x34f0, 0x4a8, 0x4fa, 0x4bc
.long 0x3110, 0x410, 0x403, 0x444
.long 0x3130, 0x410, 0x423, 0x444
.long 0x3150, 0x410, 0x40b, 0x464
.long 0x3170, 0x410, 0x42b, 0x464
.long 0x3190, 0x430, 0x483, 0x44c
.long 0x31b0, 0x430, 0x4a3, 0x44c
.long 0x31d0, 0x430, 0x48b, 0x46c
.long 0x31f0, 0x430, 0x4ab, 0x46c
.long 0x3200, 0x418, 0x413, 0x4c4
.long 0x3220, 0x418, 0x433, 0x4c4
.long 0x3240, 0x418, 0x41b, 0x4e4
.long 0x3260, 0x418, 0x43b, 0x4e4
.long 0x3280, 0x438, 0x493, 0x4cc
.long 0x32a0, 0x438, 0x4b3, 0x4cc
.long 0x32c0, 0x438, 0x49b, 0x4ec
.long 0x32e0, 0x438, 0x4bb, 0x4ec
.long 0x3310, 0x490, 0x443, 0x454
.long 0x3330, 0x490, 0x463, 0x454
.long 0x3350, 0x490, 0x44b, 0x474
.long 0x3370, 0x490, 0x46b, 0x474
.long 0x3390, 0x4b0, 0x4c3, 0x45c
.long 0x33b0, 0x4b0, 0x4e3, 0x45c
.long 0x33d0, 0x4b0, 0x4cb, 0x47c
.long 0x33f0, 0x4b0, 0x4eb, 0x47c
.long 0x3400, 0x498, 0x453, 0x4d4
.long 0x3420, 0x498, 0x473, 0x4d4
.long 0x3440, 0x498, 0x45b, 0x4f4
.long 0x3460, 0x498, 0x47b, 0x4f4
.long 0x3480, 0x4b8, 0x4d3, 0x4dc
.long 0x34a0, 0x4b8, 0x4f3, 0x4dc
.long 0x34c0, 0x4b8, 0x4db, 0x4fc
.long 0x34e0, 0x4b8, 0x4fb, 0x4fc
.long 0x17500, 0x0, 0x4500, 0x100000
.long 0x17540, 0x0, 0x4502, 0x200000
.long 0x17580, 0x0, 0x4504, 0x300000
.long 0x175c0, 0x0, 0x4506, 0x400000
.long 0x17610, 0xa00, 0x4510, 0x10000000
.long 0x17650, 0xa00, 0x4512, 0x20000000
.long 0x17690, 0xa00, 0x4514, 0x30000000
.long 0x176d0, 0xa00, 0x4516, 0x40000000
.long 0x17720, 0x1400, 0x4508, 0x500000
.long 0x17760, 0x1400, 0x450a, 0x600000
.long 0x177a0, 0x1400, 0x450c, 0x700000
.long 0x177e0, 0x1400, 0x450e, 0x800000
.long 0x17830, 0x1e00, 0x4518, 0x50000000
.long 0x17870, 0x1e00, 0x451a, 0x60000000
.long 0x178b0, 0x1e00, 0x451c, 0x70000000
.long 0x178f0, 0x1e00, 0x451e, 0x80000000
.long 0x17900, 0x2800, 0x5100, 0x100000
.long 0x17940, 0x2800, 0x5102, 0x200000
.long 0x17980, 0x2800, 0x5104, 0x300000
.long 0x179c0, 0x2800, 0x5106, 0x400000
.long 0x17a10, 0x3200, 0x5110, 0x10000000
.long 0x17a50, 0x3200, 0x5112, 0x100000
.long 0x17a90, 0x3200, 0x5114, 0x200000
.long 0x17ad0, 0x3200, 0x5116, 0x300000
.long 0x17b20, 0x3c00, 0x5108, 0x400000
.long 0x17b60, 0x3c00, 0x510a, 0x10000000
.long 0x17ba0, 0x3c00, 0x510c, 0x20000000
.long 0x17be0, 0x3c00, 0x510e, 0x30000000
.long 0x17c30, 0x4600, 0x5118, 0x40000000
.long 0x17c70, 0x4600, 0x511a, 0x500000
.long 0x17cb0, 0x4600, 0x511c, 0x600000
.long 0x17cf0, 0x4600, 0x511e, 0x700000
.long 0x17520, 0x5000, 0x5d00, 0x800000
.long 0x17560, 0x5000, 0x5d02, 0x50000000
.long 0x175a0, 0x5000, 0x5d04, 0x60000000
.long 0x175e0, 0x5000, 0x5d06, 0x70000000
.long 0x17630, 0x5a00, 0x5d10, 0x80000000
.long 0x17670, 0x5a00, 0x5d12, 0x100000
.long 0x176b0, 0x5a00, 0x5d14, 0x200000
.long 0x176f0, 0x5a00, 0x5d16, 0x300000
.long 0x17700, 0x6400, 0x5d08, 0x0
.long 0x17740, 0x6400, 0x5d0a, 0x0
.long 0x17780, 0x6400, 0x5d0c, 0x0
.long 0x177c0, 0x6400, 0x5d0e, 0x0
.long 0x17810, 0x6e00, 0x5d18, 0x0
.long 0x17850, 0x6e00, 0x5d1a, 0x0
.long 0x17890, 0x6e00, 0x5d1c, 0x0
.long 0x178d0, 0x6e00, 0x5d1e, 0x0
.long 0x17920, 0x7800, 0x6900, 0x0
.long 0x17960, 0x7800, 0x6902, 0x0
.long 0x179a0, 0x7800, 0x6904, 0x0
.long 0x179e0, 0x7800, 0x6906, 0x0
.long 0x17a30, 0x8200, 0x6910, 0x0
.long 0x17a70, 0x8200, 0x6912, 0x0
.long 0x17ab0, 0x8200, 0x6914, 0x0
.long 0x17af0, 0x8200, 0x6916, 0x0
.long 0x17b00, 0x8c00, 0x6908, 0x0
.long 0x17b40, 0x8c00, 0x690a, 0x0
.long 0x17b80, 0x8c00, 0x690c, 0x0
.long 0x17bc0, 0x8c00, 0x690e, 0x0
.long 0x17c10, 0x9600, 0x6918, 0x0
.long 0x17c50, 0x9600, 0x691a, 0x0
.long 0x17c90, 0x9600, 0x691c, 0x0
.long 0x17cd0, 0x9600, 0x691e, 0x0
.long 0x10, 0x1c0, 0x0, 0x0
.long 0x20, 0x1c4, 0x10, 0x10
.long 0x30, 0x1c8, 0x20, 0x0
.long 0x40, 0x1cc, 0x30, 0x10
.long 0x0, 0x1c0, 0x0, 0x0
.long 0x0, 0x1c4, 0x10, 0x10
.long 0x0, 0x1c8, 0x20, 0x0
.long 0x0, 0x1cc, 0x30, 0x10
.long 0x50, 0x1c0, 0x0, 0x0
.long 0x60, 0x1c4, 0x10, 0x10
.long 0x70, 0x1c8, 0x20, 0x0
.long 0x80, 0x1cc, 0x30, 0x10
.long 0x0, 0x1c0, 0x0, 0x0
.long 0x0, 0x1c4, 0x10, 0x10
.long 0x0, 0x1c8, 0x20, 0x0
.long 0x0, 0x1cc, 0x30, 0x10
.long 0x0, 0x1c0, 0x10, 0x10
.long 0x0, 0x1c4, 0x0, 0x0
.long 0x0, 0x1c8, 0x30, 0x10
.long 0x0, 0x1cc, 0x20, 0x0
.long 0x0, 0x1c0, 0x10, 0x10
.long 0x0, 0x1c4, 0x0, 0x0
.long 0x0, 0x1c8, 0x30, 0x10
.long 0x0, 0x1cc, 0x20, 0x0
.long 0x0, 0x1c0, 0x10, 0x10
.long 0x0, 0x1c4, 0x0, 0x0
.long 0x0, 0x1c8, 0x30, 0x10
.long 0x0, 0x1cc, 0x20, 0x0
.long 0x0, 0x1c0, 0x10, 0x10
.long 0x0, 0x1c4, 0x0, 0x0
.long 0x0, 0x1c8, 0x30, 0x10
.long 0x0, 0x1cc, 0x20, 0x0
.long 0x0, 0x1c0, 0x20, 0x0
.long 0x0, 0x1c4, 0x30, 0x10
.long 0x0, 0x1c8, 0x0, 0x0
.long 0x0, 0x1cc, 0x10, 0x10
.long 0x10, 0x1c0, 0x20, 0x0
.long 0x20, 0x1c4, 0x30, 0x10
.long 0x30, 0x1c8, 0x0, 0x0
.long 0x40, 0x1cc, 0x10, 0x10
.long 0x0, 0x1c0, 0x20, 0x0
.long 0x0, 0x1c4, 0x30, 0x10
.long 0x0, 0x1c8, 0x0, 0x0
.long 0x0, 0x1cc, 0x10, 0x10
.long 0x50, 0x1c0, 0x20, 0x0
.long 0x60, 0x1c4, 0x30, 0x10
.long 0x70, 0x1c8, 0x0, 0x0
.long 0x80, 0x1cc, 0x10, 0x10
.long 0x0, 0x1c0, 0x30, 0x10
.long 0x0, 0x1c4, 0x20, 0x0
.long 0x0, 0x1c8, 0x10, 0x10
.long 0x0, 0x1cc, 0x0, 0x0
.long 0x0, 0x1c0, 0x30, 0x10
.long 0x0, 0x1c4, 0x20, 0x0
.long 0x0, 0x1c8, 0x10, 0x10
.long 0x0, 0x1cc, 0x0, 0x0
.long 0x0, 0x1c0, 0x30, 0x10
.long 0x0, 0x1c4, 0x20, 0x0
.long 0x0, 0x1c8, 0x10, 0x10
.long 0x0, 0x1cc, 0x0, 0x0
.long 0x0, 0x1c0, 0x30, 0x10
.long 0x0, 0x1c4, 0x20, 0x0
.long 0x0, 0x1c8, 0x10, 0x10
.long 0x0, 0x1cc, 0x0, 0x0
.long 0x0, 0x0, 0x0, 0x0
.long 0x0, 0x8, 0x100, 0x100
.long 0x0, 0x10, 0x200, 0x200
.long 0x0, 0x18, 0x300, 0x300
.long 0x0, 0x140, 0x400, 0x400
.long 0x0, 0x148, 0x500, 0x500
.long 0x0, 0x150, 0x600, 0x600
.long 0x0, 0x158, 0x700, 0x700
.long 0x0, 0x280, 0x800, 0x800
.long 0x0, 0x288, 0x900, 0x900
.long 0x0, 0x290, 0xa00, 0xa00
.long 0x0, 0x298, 0xb00, 0xb00
.long 0x0, 0x3c0, 0xc00, 0xc00
.long 0x0, 0x3c8, 0xd00, 0xd00
.long 0x0, 0x3d0, 0xe00, 0xe00
.long 0x0, 0x3d8, 0xf00, 0xf00
.long 0x10, 0x20, 0x1000, 0x1000
.long 0x20, 0x28, 0x1100, 0x1100
.long 0x30, 0x30, 0x1200, 0x1200
.long 0x40, 0x38, 0x1300, 0x40000000
.long 0x0, 0x160, 0x1400, 0x40000000
.long 0x0, 0x168, 0x40000000, 0x40000000
.long 0x0, 0x170, 0x40000000, 0x40000000
.long 0x0, 0x178, 0x40000000, 0x40000000
.long 0x50, 0x2a0, 0x40000000, 0x40000000
.long 0x60, 0x2a8, 0x40000000, 0x40000000
.long 0x70, 0x2b0, 0x40000000, 0x40000000
.long 0x80, 0x2b8, 0x40000000, 0x40000000
.long 0x0, 0x3e0, 0x40000000, 0x40000000
.long 0x0, 0x3e8, 0x40000000, 0x40000000
.long 0x0, 0x3f0, 0x40000000, 0x40000000
.long 0x0, 0x3f8, 0x40000000, 0x40000000
.long 0x0, 0x0, 0x10, 0x10
.long 0x0, 0x8, 0x110, 0x110
.long 0x0, 0x10, 0x210, 0x210
.long 0x0, 0x18, 0x310, 0x310
.long 0x0, 0x140, 0x410, 0x410
.long 0x0, 0x148, 0x510, 0x510
.long 0x0, 0x150, 0x610, 0x610
.long 0x0, 0x158, 0x710, 0x710
.long 0x0, 0x280, 0x810, 0x810
.long 0x0, 0x288, 0x910, 0x910
.long 0x0, 0x290, 0xa10, 0xa10
.long 0x0, 0x298, 0xb10, 0xb10
.long 0x0, 0x3c0, 0xc10, 0xc10
.long 0x0, 0x3c8, 0xd10, 0xd10
.long 0x0, 0x3d0, 0xe10, 0xe10
.long 0x0, 0x3d8, 0xf10, 0xf10
.long 0x0, 0x20, 0x1010, 0x1010
.long 0x0, 0x28, 0x1110, 0x1110
.long 0x0, 0x30, 0x1210, 0x1210
.long 0x0, 0x38, 0x1310, 0x40000000
.long 0x10, 0x160, 0x1410, 0x40000000
.long 0x20, 0x168, 0x40000000, 0x40000000
.long 0x30, 0x170, 0x40000000, 0x40000000
.long 0x40, 0x178, 0x40000000, 0x40000000
.long 0x0, 0x2a0, 0x40000000, 0x40000000
.long 0x0, 0x2a8, 0x40000000, 0x40000000
.long 0x0, 0x2b0, 0x40000000, 0x40000000
.long 0x0, 0x2b8, 0x40000000, 0x40000000
.long 0x50, 0x3e0, 0x40000000, 0x40000000
.long 0x60, 0x3e8, 0x40000000, 0x40000000
.long 0x70, 0x3f0, 0x40000000, 0x40000000
.long 0x80, 0x3f8, 0x40000000, 0x40000000
.long 0x0, 0x0, 0x0, 0x0
.long 0x3f80, 0x0, 0x0, 0x0
.long 0x3f800000, 0x0, 0x0, 0x0
.long 0x0, 0x3f80, 0x0, 0x0
.long 0x0, 0x3f800000, 0x0, 0x0
.long 0x0, 0x0, 0x3f80, 0x0
.long 0x0, 0x0, 0x3f800000, 0x0
.long 0x0, 0x0, 0x0, 0x3f80
.long 0x0, 0x0, 0x0, 0x3f800000
.long 0x0, 0x0, 0x0, 0x0
.long 0x0, 0x0, 0x0, 0x0
.long 0x0, 0x0, 0x0, 0x0
.long 0x0, 0x0, 0x0, 0x0
.long 0x0, 0x0, 0x0, 0x0
.long 0x0, 0x0, 0x0, 0x0
.long 0x0, 0x0, 0x0, 0x0
.long 0x0, 0x0, 0x0, 0x0
.long 0x0, 0x0, 0x0, 0x0
.long 0x0, 0x0, 0x0, 0x0
.long 0x0, 0x0, 0x0, 0x0
.long 0x0, 0x0, 0x0, 0x0
.long 0x0, 0x0, 0x0, 0x0
.long 0x0, 0x0, 0x0, 0x0
.long 0x0, 0x0, 0x0, 0x0
.long 0x0, 0x0, 0x0, 0x0
.long 0x0, 0x0, 0x0, 0x0
.long 0x0, 0x0, 0x0, 0x0
.long 0x0, 0x0, 0x0, 0x0
.long 0x0, 0x0, 0x0, 0x0
.long 0x0, 0x0, 0x0, 0x0
.long 0x0, 0x0, 0x0, 0x0
.long 0x0, 0x0, 0x0, 0x0
.long 0xffffffff, 0xffffffff, 0xffffffff, 0xffffffff
.long 0xffffffff, 0xffffffff, 0xffffffff, 0xffffffff
.long 0xffffffff, 0xffffffff, 0xffffffff, 0xffffffff
.long 0xffffffff, 0xffffffff, 0xffffffff, 0xffffffff
.long 0xffffffff, 0xffffffff, 0xffffffff, 0xffffffff
.long 0xffffffff, 0xffffffff, 0xffffffff, 0xffffffff
.long 0xffffffff, 0xffffffff, 0xffffffff, 0xffffffff
.long 0xffffffff, 0xffffffff, 0xffffffff, 0xffffffff
.long 0xffffffff, 0xffffffff, 0xffffffff, 0xffffffff
.long 0xffffffff, 0xffffffff, 0xffffffff, 0xffffffff
.long 0xffffffff, 0xffffffff, 0xffffffff, 0xffffffff
.long 0xffffffff, 0xffffffff, 0xffffffff, 0xffffffff
.long 0xffffffff, 0xffffffff, 0xffffffff, 0xffffffff
.long 0xffffffff, 0xffffffff, 0xffffffff, 0xffffffff
.long 0xffffffff, 0xffffffff, 0xffffffff, 0xffffffff
.long 0xffffffff, 0xffffffff, 0xffffffff, 0xffffffff
.long 0xffffffff, 0xffffffff, 0xffffffff, 0xffffffff
.long 0xffffffff, 0xffffffff, 0xffffffff, 0xffffffff
.long 0xffffffff, 0xffffffff, 0xffffffff, 0xffffffff
.long 0xffffffff, 0xffffffff, 0xffffffff, 0xffffffff
.long 0xffffffff, 0xffffffff, 0xffffffff, 0xffffffff
.long 0xffffffff, 0xffffffff, 0xffffffff, 0xffffffff
.long 0xffffffff, 0xffffffff, 0xffffffff, 0xffffffff
.long 0xffffffff, 0xffffffff, 0xffffffff, 0xffffffff
.long 0xffffffff, 0xffffffff, 0xffffffff, 0xffffffff
.long 0xffffffff, 0xffffffff, 0xffffffff, 0xffffffff
.long 0xffffffff, 0xffffffff, 0xffffffff, 0xffffffff
.long 0xffffffff, 0xffffffff, 0xffffffff, 0xffffffff
.long 0xffffffff, 0xffffffff, 0xffffffff, 0xffffffff
.long 0xffffffff, 0xffffffff, 0xffffffff, 0xffffffff
.long 0xffffffff, 0xffffffff, 0xffffffff, 0xffffffff
.long 0xffffffff, 0xffffffff, 0xffffffff, 0xffffffff
.long 0xffff, 0xffffffff, 0xffff, 0xffffffff
.long 0xffff, 0xffffffff, 0xffff, 0xffffffff
.long 0xffff, 0xffffffff, 0xffff, 0xffffffff
.long 0xffff, 0xffffffff, 0xffff, 0xffffffff
.long 0xffff, 0xffffffff, 0xffff, 0xffffffff
.long 0xffff, 0xffffffff, 0xffff, 0xffffffff
.long 0xffff, 0xffffffff, 0xffff, 0xffffffff
.long 0xffff, 0xffffffff, 0xffff, 0xffffffff
.long 0xffff, 0xffffffff, 0xffff, 0xffffffff
.long 0xffff, 0xffffffff, 0xffff, 0xffffffff
.long 0xffff, 0xffffffff, 0xffff, 0xffffffff
.long 0xffff, 0xffffffff, 0xffff, 0xffffffff
.long 0xffff, 0xffffffff, 0xffff, 0xffffffff
.long 0xffff, 0xffffffff, 0xffff, 0xffffffff
.long 0xffff, 0xffffffff, 0xffff, 0xffffffff
.long 0xffff, 0xffffffff, 0xffff, 0xffffffff
.long 0xffff, 0xffffffff, 0xffff, 0xffffffff
.long 0xffff, 0xffffffff, 0xffff, 0xffffffff
.long 0xffff, 0xffffffff, 0xffff, 0xffffffff
.long 0xffff, 0xffffffff, 0xffff, 0xffffffff
.long 0xffff, 0xffffffff, 0xffff, 0xffffffff
.long 0xffff, 0xffffffff, 0xffff, 0xffffffff
.long 0xffff, 0xffffffff, 0xffff, 0xffffffff
.long 0xffff, 0xffffffff, 0xffff, 0xffffffff
.long 0xffff, 0xffffffff, 0xffff, 0xffffffff
.long 0xffff, 0xffffffff, 0xffff, 0xffffffff
.long 0xffff, 0xffffffff, 0xffff, 0xffffffff
.long 0xffff, 0xffffffff, 0xffff, 0xffffffff
.long 0xffff, 0xffffffff, 0xffff, 0xffffffff
.long 0xffff, 0xffffffff, 0xffff, 0xffffffff
.long 0xffff, 0xffffffff, 0xffff, 0xffffffff
.long 0xffff, 0xffffffff, 0xffff, 0xffffffff
.long 0xffff, 0xffffffff, 0xffff, 0xffffffff
.long 0xffff, 0xffffffff, 0xffff, 0xffffffff
.long 0xffff, 0xffffffff, 0xffff, 0xffffffff
.long 0xffff, 0xffffffff, 0xffff, 0xffffffff
.long 0xffff, 0xffffffff, 0xffff, 0xffffffff
.long 0xffff, 0xffffffff, 0xffff, 0xffffffff
.long 0xffff, 0xffffffff, 0xffff, 0xffffffff
.long 0xffff, 0xffffffff, 0xffff, 0xffffffff
.long 0xffff, 0xffffffff, 0xffff, 0xffffffff
.long 0xffff, 0xffffffff, 0xffff, 0xffffffff
.long 0xffff, 0xffffffff, 0xffff, 0xffffffff
.long 0xffff, 0xffffffff, 0xffff, 0xffffffff
.long 0xffff, 0xffffffff, 0xffff, 0xffffffff
.long 0xffff, 0xffffffff, 0xffff, 0xffffffff
.long 0xffff, 0xffffffff, 0xffff, 0xffffffff
.long 0xffff, 0xffffffff, 0xffff, 0xffffffff
.long 0xffff, 0xffffffff, 0xffff, 0xffffffff
.long 0xffff, 0xffffffff, 0xffff, 0xffffffff
.long 0xffff, 0xffffffff, 0xffff, 0xffffffff
.long 0xffff, 0xffffffff, 0xffff, 0xffffffff
.long 0xffff, 0xffffffff, 0xffff, 0xffffffff
.long 0xffff, 0xffffffff, 0xffff, 0xffffffff
.long 0xffff, 0xffffffff, 0xffff, 0xffffffff
.long 0xffff, 0xffffffff, 0xffff, 0xffffffff
.long 0xffff, 0xffffffff, 0xffff, 0xffffffff
.long 0xffff, 0xffffffff, 0xffff, 0xffffffff
.long 0xffff, 0xffffffff, 0xffff, 0xffffffff
.long 0xffff, 0xffffffff, 0xffff, 0xffffffff
.long 0xffff, 0xffffffff, 0xffff, 0xffffffff
.long 0xffff, 0xffffffff, 0xffff, 0xffffffff
.long 0xffff, 0xffffffff, 0xffff, 0xffffffff
.long 0xffff, 0xffffffff, 0xffff, 0xffffffff
.p2align 6
.amdhsa_kernel standalone__mpnn_edge_mlp__graph_kernel
  .amdhsa_next_free_vgpr 252
  .amdhsa_next_free_sgpr 102
  .amdhsa_accum_offset 252
  .amdhsa_group_segment_fixed_size 0
  .amdhsa_kernarg_size 72
  .amdhsa_user_sgpr_count 2
  .amdhsa_user_sgpr_kernarg_segment_ptr 1
  .amdhsa_system_sgpr_workgroup_id_x 1
.end_amdhsa_kernel
```
